```python
import torch

def _softmax(x, axis=-1):
    return torch.softmax(x, dim=axis)
def _gelu(x):
    return torch.nn.functional.gelu(x, approximate="tanh")
def _silu(x):
    return torch.nn.functional.silu(x)
def _sigmoid(x):
    return torch.sigmoid(x)
def _layernorm(x, axis=-1, eps=1e-5):
    m = x.mean(dim=axis, keepdim=True)
    v = x.var(dim=axis, keepdim=True, unbiased=False)
    return (x - m) / torch.sqrt(v + eps)
def _scatter_add(tgt, idx, src, axis=0):
    return tgt.clone().index_add_(axis, idx, src)
def _segment_sum(src, seg, n):
    out = torch.zeros((n,) + src.shape[1:], dtype=src.dtype)
    return out.index_add_(0, seg, src)
def _pad(x, pw):
    flat = tuple(v for pair in reversed(pw) for v in pair)
    return torch.nn.functional.pad(x, flat)

kernel_name = 'sequential_preLN__softmax_full_mha__moe_arch_mod__prompt'

def setup_inputs():

    _w = (lambda a: (lambda t: t.to(torch.bfloat16) if t.is_floating_point() else t)(torch.as_tensor(a)))
    def _A_setup():
        B, S, D = 1, 2048, 512
        return {
            "x": _w((lambda *s: torch.randn(*s, dtype=torch.bfloat16) * 0.05)(B, S, D)),
            "wqkv": _w((lambda *s: torch.randn(*s, dtype=torch.bfloat16) * 0.05)(D, 3 * D)),
            "wo": _w((lambda *s: torch.randn(*s, dtype=torch.bfloat16) * 0.05)(D, D)),
        }
    _A_in = _A_setup()

    def _B_setup():
        B, S, D, F, C = 1, 2048, 512, 1792, 2
        return {
            "x": _w((lambda *s: torch.randn(*s, dtype=torch.bfloat16) * 0.05)(B, S, D)),
            "w_r": _w((lambda *s: torch.randn(*s, dtype=torch.bfloat16) * 0.05)(D)),
            "w_gate": _w((lambda *s: torch.randn(*s, dtype=torch.bfloat16) * 0.05)(D, F)),
            "w_up": _w((lambda *s: torch.randn(*s, dtype=torch.bfloat16) * 0.05)(D, F)),
            "w_down": _w((lambda *s: torch.randn(*s, dtype=torch.bfloat16) * 0.05)(F, D)),
        }
    _B_in = _B_setup()

    return {
        "A_x": _A_in["x"],
        "A_wqkv": _A_in["wqkv"],
        "A_wo": _A_in["wo"],
        "B_x": _B_in["x"],
        "B_w_r": _B_in["w_r"],
        "B_w_gate": _B_in["w_gate"],
        "B_w_up": _B_in["w_up"],
        "B_w_down": _B_in["w_down"],
    }

def reference(A_x, A_wqkv, A_wo, B_x, B_w_r, B_w_gate, B_w_up, B_w_down):
    def _A_ref(x, wqkv, wo):
        B, S, D = x.shape
        H = 32; Dh = D // H
        qkv = (lambda x, *d: x.permute(*d))((x @ wqkv).reshape(B, S, 3, H, Dh), 2, 0, 3, 1, 4)
        q, k, v = qkv[0], qkv[1], qkv[2]
        scale = Dh ** -0.5
        scores = torch.einsum("bhqd,bhkd->bhqk", q, k) * scale
        p = _softmax(scores, axis=-1)
        o = torch.einsum("bhqk,bhkd->bhqd", p, v)
        return (lambda x, *d: x.permute(*d))(o, 0, 2, 1, 3).reshape(B, S, D) @ wo

    def _B_ref(x, w_r, w_gate, w_up, w_down):
        B, S, D = x.shape
        C = 2
        r = x @ w_r
        idx = torch.argsort(-r, axis=-1)[:, :C]
        idx_e = (lambda x, n, axis: torch.repeat_interleave(x, n, dim=axis))(idx.reshape(B, C, 1), D, axis=2)
        x_sel = (lambda x, i, axis: torch.take_along_dim(x, i, dim=axis))(x, idx_e, axis=1)
        g = _silu(x_sel @ w_gate)
        u = x_sel @ w_up
        y = (g * u) @ w_down
        r_sel = _sigmoid((lambda x, i, axis: torch.take_along_dim(x, i, dim=axis))(r, idx, axis=1))
        y = y * r_sel.reshape(B, C, 1)
        b_off = (torch.arange(B) * S).reshape(B, 1)
        flat_idx = (idx + b_off).reshape(B * C)
        zero = (x * 0.0).reshape(B * S, D)
        upd = _scatter_add(zero, flat_idx, y.reshape(B * C, D), axis=0)
        return x + upd.reshape(B, S, D)

    x = A_x
    h = x + _A_ref(_layernorm(x, axis=-1), A_wqkv, A_wo)
    h2 = h + _B_ref(_layernorm(h, axis=-1), B_w_r, B_w_gate, B_w_up, B_w_down)
    return h2
```

```asm
; @launch kernel=k1_kernel grid=(256,1,1) block=(768,1,1) lds=140288
; @launch kernel=k2_kernel grid=(256,1,1) block=(1024,1,1) lds=160768
; @launch kernel=k3_kernel grid=(256,1,1) block=(256,1,1) lds=132096
; @launch kernel=k4_kernel grid=(88,1,1) block=(1024,1,1) lds=65536
.amdgcn_target "amdgcn-amd-amdhsa--gfx950"
.text
.globl k1_kernel
.p2align 8
.type k1_kernel,@function
k1_kernel:
    s_cmp_ge_u32 s2, 256
    s_cbranch_scc1 K1_END
    s_load_dwordx4 s[4:7], s[0:1], 0
    s_load_dwordx2 s[8:9], s[0:1], 80
    v_lshrrev_b32 v1, 6, v0
    v_and_b32 v2, 63, v0
    s_nop 0
    v_readfirstlane_b32 s20, v1
    s_bfe_u32 s21, s2, 0x20001
    s_lshl_b32 s21, s21, 3
    s_bfe_u32 s22, s2, 0x30003
    s_add_u32 s21, s21, s22
    s_and_b32 s22, s2, 1
    s_lshl_b32 s22, s22, 2
    s_lshr_b32 s23, s2, 6
    s_add_u32 s22, s22, s23
    s_waitcnt lgkmcnt(0)
    s_mov_b32 s12, s4
    s_mov_b32 s13, s5
    s_mov_b32 s14, 0x200000
    s_mov_b32 s15, 0x00020000
    s_mov_b32 s16, s6
    s_mov_b32 s17, s7
    s_mov_b32 s18, 0x180000
    s_mov_b32 s19, 0x00020000
    s_mov_b32 s24, s8
    s_mov_b32 s25, s9
    s_mov_b32 s26, 0x1000000
    s_mov_b32 s27, 0x00020000
    v_lshrrev_b32 v4, 3, v2
    v_and_b32 v5, 7, v2
    s_cmp_ge_u32 s20, 8
    s_cbranch_scc1 K1_NOX
    s_lshl_b32 s23, s21, 6
    s_lshl_b32 s31, s20, 3
    s_add_u32 s23, s23, s31
    v_add_u32 v3, s23, v4
    v_lshlrev_b32 v3, 10, v3
    v_lshl_add_u32 v3, v5, 4, v3
    buffer_load_dwordx4 v[64:67], v3, s[12:15], 0 offen offset:0
    buffer_load_dwordx4 v[68:71], v3, s[12:15], 0 offen offset:128
    buffer_load_dwordx4 v[72:75], v3, s[12:15], 0 offen offset:256
    buffer_load_dwordx4 v[76:79], v3, s[12:15], 0 offen offset:384
    buffer_load_dwordx4 v[80:83], v3, s[12:15], 0 offen offset:512
    buffer_load_dwordx4 v[84:87], v3, s[12:15], 0 offen offset:640
    buffer_load_dwordx4 v[88:91], v3, s[12:15], 0 offen offset:768
    buffer_load_dwordx4 v[92:95], v3, s[12:15], 0 offen offset:896
K1_NOX:
    s_lshl_b32 s31, s20, 7
    s_movk_i32 s33, 2731
    s_mul_i32 s34, s22, 384
    v_add_u32 v6, s31, v2
    v_mul_lo_u32 v7, v6, s33
    v_lshrrev_b32 v7, 16, v7
    v_mul_u32_u24 v8, 24, v7
    v_sub_u32 v8, v6, v8
    v_lshrrev_b32 v9, 2, v8
    v_bfe_u32 v16, v7, 1, 1
    v_xor_b32 v9, v9, v16
    v_and_b32 v8, 3, v8
    v_mul_u32_u24 v7, 3072, v7
    v_lshl_add_u32 v7, v9, 6, v7
    v_lshl_add_u32 v7, v8, 4, v7
    v_add_u32 v10, s34, v7
    v_add_u32 v6, s31, v2
    v_add_u32 v6, 64, v6
    v_mul_lo_u32 v7, v6, s33
    v_lshrrev_b32 v7, 16, v7
    v_mul_u32_u24 v8, 24, v7
    v_sub_u32 v8, v6, v8
    v_lshrrev_b32 v9, 2, v8
    v_bfe_u32 v16, v7, 1, 1
    v_xor_b32 v9, v9, v16
    v_and_b32 v8, 3, v8
    v_mul_u32_u24 v7, 3072, v7
    v_lshl_add_u32 v7, v9, 6, v7
    v_lshl_add_u32 v7, v8, 4, v7
    v_add_u32 v11, s34, v7
    s_lshl_b32 s35, s20, 11
    s_mov_b32 s36, 0
    s_add_u32 m0, s35, 0
    s_nop 0
    buffer_load_dwordx4 v10, s[16:19], s36 offen lds
    s_add_u32 m0, s35, 1024
    s_nop 0
    buffer_load_dwordx4 v11, s[16:19], s36 offen lds
    s_mov_b32 s36, 196608
    s_add_u32 m0, s35, 24576
    s_nop 0
    buffer_load_dwordx4 v10, s[16:19], s36 offen lds
    s_add_u32 m0, s35, 25600
    s_nop 0
    buffer_load_dwordx4 v11, s[16:19], s36 offen lds
    s_mov_b32 s36, 393216
    s_add_u32 m0, s35, 49152
    s_nop 0
    buffer_load_dwordx4 v10, s[16:19], s36 offen lds
    s_add_u32 m0, s35, 50176
    s_nop 0
    buffer_load_dwordx4 v11, s[16:19], s36 offen lds
    s_cmp_ge_u32 s20, 8
    s_cbranch_scc1 K1_IDLE
    s_mov_b32 s38, 0x3f803f80
    v_mov_b32 v17, s38
    v_mov_b32 v32, 0
    v_mov_b32 v33, 0
    v_mov_b32 v34, 0
    v_mov_b32 v35, 0
    s_lshl_b32 s31, s20, 3
    v_add_u32 v18, s31, v4
    v_mul_u32_u24 v18, 1040, v18
    v_lshl_add_u32 v18, v5, 4, v18
    v_add_u32 v18, 73728, v18
    s_waitcnt vmcnt(6)
    v_dot2_f32_bf16 v32, v64, v17, v32
    v_dot2_f32_bf16 v34, v64, v64, v34
    v_dot2_f32_bf16 v33, v65, v17, v33
    v_dot2_f32_bf16 v35, v65, v65, v35
    v_dot2_f32_bf16 v32, v66, v17, v32
    v_dot2_f32_bf16 v34, v66, v66, v34
    v_dot2_f32_bf16 v33, v67, v17, v33
    v_dot2_f32_bf16 v35, v67, v67, v35
    v_dot2_f32_bf16 v32, v68, v17, v32
    v_dot2_f32_bf16 v34, v68, v68, v34
    v_dot2_f32_bf16 v33, v69, v17, v33
    v_dot2_f32_bf16 v35, v69, v69, v35
    v_dot2_f32_bf16 v32, v70, v17, v32
    v_dot2_f32_bf16 v34, v70, v70, v34
    v_dot2_f32_bf16 v33, v71, v17, v33
    v_dot2_f32_bf16 v35, v71, v71, v35
    v_dot2_f32_bf16 v32, v72, v17, v32
    v_dot2_f32_bf16 v34, v72, v72, v34
    v_dot2_f32_bf16 v33, v73, v17, v33
    v_dot2_f32_bf16 v35, v73, v73, v35
    v_dot2_f32_bf16 v32, v74, v17, v32
    v_dot2_f32_bf16 v34, v74, v74, v34
    v_dot2_f32_bf16 v33, v75, v17, v33
    v_dot2_f32_bf16 v35, v75, v75, v35
    v_dot2_f32_bf16 v32, v76, v17, v32
    v_dot2_f32_bf16 v34, v76, v76, v34
    v_dot2_f32_bf16 v33, v77, v17, v33
    v_dot2_f32_bf16 v35, v77, v77, v35
    v_dot2_f32_bf16 v32, v78, v17, v32
    v_dot2_f32_bf16 v34, v78, v78, v34
    v_dot2_f32_bf16 v33, v79, v17, v33
    v_dot2_f32_bf16 v35, v79, v79, v35
    v_dot2_f32_bf16 v32, v80, v17, v32
    v_dot2_f32_bf16 v34, v80, v80, v34
    v_dot2_f32_bf16 v33, v81, v17, v33
    v_dot2_f32_bf16 v35, v81, v81, v35
    v_dot2_f32_bf16 v32, v82, v17, v32
    v_dot2_f32_bf16 v34, v82, v82, v34
    v_dot2_f32_bf16 v33, v83, v17, v33
    v_dot2_f32_bf16 v35, v83, v83, v35
    v_dot2_f32_bf16 v32, v84, v17, v32
    v_dot2_f32_bf16 v34, v84, v84, v34
    v_dot2_f32_bf16 v33, v85, v17, v33
    v_dot2_f32_bf16 v35, v85, v85, v35
    v_dot2_f32_bf16 v32, v86, v17, v32
    v_dot2_f32_bf16 v34, v86, v86, v34
    v_dot2_f32_bf16 v33, v87, v17, v33
    v_dot2_f32_bf16 v35, v87, v87, v35
    v_dot2_f32_bf16 v32, v88, v17, v32
    v_dot2_f32_bf16 v34, v88, v88, v34
    v_dot2_f32_bf16 v33, v89, v17, v33
    v_dot2_f32_bf16 v35, v89, v89, v35
    v_dot2_f32_bf16 v32, v90, v17, v32
    v_dot2_f32_bf16 v34, v90, v90, v34
    v_dot2_f32_bf16 v33, v91, v17, v33
    v_dot2_f32_bf16 v35, v91, v91, v35
    v_dot2_f32_bf16 v32, v92, v17, v32
    v_dot2_f32_bf16 v34, v92, v92, v34
    v_dot2_f32_bf16 v33, v93, v17, v33
    v_dot2_f32_bf16 v35, v93, v93, v35
    v_dot2_f32_bf16 v32, v94, v17, v32
    v_dot2_f32_bf16 v34, v94, v94, v34
    v_dot2_f32_bf16 v33, v95, v17, v33
    v_dot2_f32_bf16 v35, v95, v95, v35
    s_nop 2
    v_add_f32 v32, v32, v33
    v_add_f32 v34, v34, v35
    s_nop 1
    v_add_f32_dpp v32, v32, v32 quad_perm:[1,0,3,2] row_mask:0xf bank_mask:0xf
    v_add_f32_dpp v34, v34, v34 quad_perm:[1,0,3,2] row_mask:0xf bank_mask:0xf
    s_nop 0
    v_add_f32_dpp v32, v32, v32 quad_perm:[2,3,0,1] row_mask:0xf bank_mask:0xf
    v_add_f32_dpp v34, v34, v34 quad_perm:[2,3,0,1] row_mask:0xf bank_mask:0xf
    s_nop 0
    v_add_f32_dpp v32, v32, v32 row_half_mirror row_mask:0xf bank_mask:0xf
    v_add_f32_dpp v34, v34, v34 row_half_mirror row_mask:0xf bank_mask:0xf
    s_nop 0
    v_mul_f32 v48, 0x3b000000, v32
    v_mul_f32 v49, 0x3b000000, v34
    v_fma_f32 v49, -v48, v48, v49
    v_max_f32 v49, 0, v49
    v_cvt_pk_bf16_f32 v50, v48, v48
    v_lshlrev_b32 v50, 16, v50
    v_cvt_pk_bf16_f32 v49, v49, v49
    v_lshlrev_b32 v49, 16, v49
    v_add_f32 v49, 0x3727c5ac, v49
    v_cvt_pk_bf16_f32 v49, v49, v49
    v_lshlrev_b32 v49, 16, v49
    v_sqrt_f32 v49, v49
    s_nop 0
    v_cvt_pk_bf16_f32 v51, v49, v49
    v_lshlrev_b32 v51, 16, v51
    v_rcp_f32 v40, v51
    s_nop 0
    v_mul_f32 v44, v50, v40
    v_sub_f32 v44, 0, v44
    v_lshlrev_b32 v52, 16, v64
    v_and_b32 v53, 0xffff0000, v64
    v_fma_f32 v52, v52, v40, v44
    v_fma_f32 v53, v53, v40, v44
    v_cvt_pk_bf16_f32 v64, v52, v53
    v_lshlrev_b32 v54, 16, v65
    v_and_b32 v55, 0xffff0000, v65
    v_fma_f32 v54, v54, v40, v44
    v_fma_f32 v55, v55, v40, v44
    v_cvt_pk_bf16_f32 v65, v54, v55
    v_lshlrev_b32 v52, 16, v66
    v_and_b32 v53, 0xffff0000, v66
    v_fma_f32 v52, v52, v40, v44
    v_fma_f32 v53, v53, v40, v44
    v_cvt_pk_bf16_f32 v66, v52, v53
    v_lshlrev_b32 v54, 16, v67
    v_and_b32 v55, 0xffff0000, v67
    v_fma_f32 v54, v54, v40, v44
    v_fma_f32 v55, v55, v40, v44
    v_cvt_pk_bf16_f32 v67, v54, v55
    ds_write_b128 v18, v[64:67] offset:0
    v_lshlrev_b32 v52, 16, v68
    v_and_b32 v53, 0xffff0000, v68
    v_fma_f32 v52, v52, v40, v44
    v_fma_f32 v53, v53, v40, v44
    v_cvt_pk_bf16_f32 v68, v52, v53
    v_lshlrev_b32 v54, 16, v69
    v_and_b32 v55, 0xffff0000, v69
    v_fma_f32 v54, v54, v40, v44
    v_fma_f32 v55, v55, v40, v44
    v_cvt_pk_bf16_f32 v69, v54, v55
    v_lshlrev_b32 v52, 16, v70
    v_and_b32 v53, 0xffff0000, v70
    v_fma_f32 v52, v52, v40, v44
    v_fma_f32 v53, v53, v40, v44
    v_cvt_pk_bf16_f32 v70, v52, v53
    v_lshlrev_b32 v54, 16, v71
    v_and_b32 v55, 0xffff0000, v71
    v_fma_f32 v54, v54, v40, v44
    v_fma_f32 v55, v55, v40, v44
    v_cvt_pk_bf16_f32 v71, v54, v55
    ds_write_b128 v18, v[68:71] offset:128
    v_lshlrev_b32 v52, 16, v72
    v_and_b32 v53, 0xffff0000, v72
    v_fma_f32 v52, v52, v40, v44
    v_fma_f32 v53, v53, v40, v44
    v_cvt_pk_bf16_f32 v72, v52, v53
    v_lshlrev_b32 v54, 16, v73
    v_and_b32 v55, 0xffff0000, v73
    v_fma_f32 v54, v54, v40, v44
    v_fma_f32 v55, v55, v40, v44
    v_cvt_pk_bf16_f32 v73, v54, v55
    v_lshlrev_b32 v52, 16, v74
    v_and_b32 v53, 0xffff0000, v74
    v_fma_f32 v52, v52, v40, v44
    v_fma_f32 v53, v53, v40, v44
    v_cvt_pk_bf16_f32 v74, v52, v53
    v_lshlrev_b32 v54, 16, v75
    v_and_b32 v55, 0xffff0000, v75
    v_fma_f32 v54, v54, v40, v44
    v_fma_f32 v55, v55, v40, v44
    v_cvt_pk_bf16_f32 v75, v54, v55
    ds_write_b128 v18, v[72:75] offset:256
    v_lshlrev_b32 v52, 16, v76
    v_and_b32 v53, 0xffff0000, v76
    v_fma_f32 v52, v52, v40, v44
    v_fma_f32 v53, v53, v40, v44
    v_cvt_pk_bf16_f32 v76, v52, v53
    v_lshlrev_b32 v54, 16, v77
    v_and_b32 v55, 0xffff0000, v77
    v_fma_f32 v54, v54, v40, v44
    v_fma_f32 v55, v55, v40, v44
    v_cvt_pk_bf16_f32 v77, v54, v55
    v_lshlrev_b32 v52, 16, v78
    v_and_b32 v53, 0xffff0000, v78
    v_fma_f32 v52, v52, v40, v44
    v_fma_f32 v53, v53, v40, v44
    v_cvt_pk_bf16_f32 v78, v52, v53
    v_lshlrev_b32 v54, 16, v79
    v_and_b32 v55, 0xffff0000, v79
    v_fma_f32 v54, v54, v40, v44
    v_fma_f32 v55, v55, v40, v44
    v_cvt_pk_bf16_f32 v79, v54, v55
    ds_write_b128 v18, v[76:79] offset:384
    v_lshlrev_b32 v52, 16, v80
    v_and_b32 v53, 0xffff0000, v80
    v_fma_f32 v52, v52, v40, v44
    v_fma_f32 v53, v53, v40, v44
    v_cvt_pk_bf16_f32 v80, v52, v53
    v_lshlrev_b32 v54, 16, v81
    v_and_b32 v55, 0xffff0000, v81
    v_fma_f32 v54, v54, v40, v44
    v_fma_f32 v55, v55, v40, v44
    v_cvt_pk_bf16_f32 v81, v54, v55
    v_lshlrev_b32 v52, 16, v82
    v_and_b32 v53, 0xffff0000, v82
    v_fma_f32 v52, v52, v40, v44
    v_fma_f32 v53, v53, v40, v44
    v_cvt_pk_bf16_f32 v82, v52, v53
    v_lshlrev_b32 v54, 16, v83
    v_and_b32 v55, 0xffff0000, v83
    v_fma_f32 v54, v54, v40, v44
    v_fma_f32 v55, v55, v40, v44
    v_cvt_pk_bf16_f32 v83, v54, v55
    ds_write_b128 v18, v[80:83] offset:512
    v_lshlrev_b32 v52, 16, v84
    v_and_b32 v53, 0xffff0000, v84
    v_fma_f32 v52, v52, v40, v44
    v_fma_f32 v53, v53, v40, v44
    v_cvt_pk_bf16_f32 v84, v52, v53
    v_lshlrev_b32 v54, 16, v85
    v_and_b32 v55, 0xffff0000, v85
    v_fma_f32 v54, v54, v40, v44
    v_fma_f32 v55, v55, v40, v44
    v_cvt_pk_bf16_f32 v85, v54, v55
    v_lshlrev_b32 v52, 16, v86
    v_and_b32 v53, 0xffff0000, v86
    v_fma_f32 v52, v52, v40, v44
    v_fma_f32 v53, v53, v40, v44
    v_cvt_pk_bf16_f32 v86, v52, v53
    v_lshlrev_b32 v54, 16, v87
    v_and_b32 v55, 0xffff0000, v87
    v_fma_f32 v54, v54, v40, v44
    v_fma_f32 v55, v55, v40, v44
    v_cvt_pk_bf16_f32 v87, v54, v55
    ds_write_b128 v18, v[84:87] offset:640
    v_lshlrev_b32 v52, 16, v88
    v_and_b32 v53, 0xffff0000, v88
    v_fma_f32 v52, v52, v40, v44
    v_fma_f32 v53, v53, v40, v44
    v_cvt_pk_bf16_f32 v88, v52, v53
    v_lshlrev_b32 v54, 16, v89
    v_and_b32 v55, 0xffff0000, v89
    v_fma_f32 v54, v54, v40, v44
    v_fma_f32 v55, v55, v40, v44
    v_cvt_pk_bf16_f32 v89, v54, v55
    v_lshlrev_b32 v52, 16, v90
    v_and_b32 v53, 0xffff0000, v90
    v_fma_f32 v52, v52, v40, v44
    v_fma_f32 v53, v53, v40, v44
    v_cvt_pk_bf16_f32 v90, v52, v53
    v_lshlrev_b32 v54, 16, v91
    v_and_b32 v55, 0xffff0000, v91
    v_fma_f32 v54, v54, v40, v44
    v_fma_f32 v55, v55, v40, v44
    v_cvt_pk_bf16_f32 v91, v54, v55
    ds_write_b128 v18, v[88:91] offset:768
    v_lshlrev_b32 v52, 16, v92
    v_and_b32 v53, 0xffff0000, v92
    v_fma_f32 v52, v52, v40, v44
    v_fma_f32 v53, v53, v40, v44
    v_cvt_pk_bf16_f32 v92, v52, v53
    v_lshlrev_b32 v54, 16, v93
    v_and_b32 v55, 0xffff0000, v93
    v_fma_f32 v54, v54, v40, v44
    v_fma_f32 v55, v55, v40, v44
    v_cvt_pk_bf16_f32 v93, v54, v55
    v_lshlrev_b32 v52, 16, v94
    v_and_b32 v53, 0xffff0000, v94
    v_fma_f32 v52, v52, v40, v44
    v_fma_f32 v53, v53, v40, v44
    v_cvt_pk_bf16_f32 v94, v52, v53
    v_lshlrev_b32 v54, 16, v95
    v_and_b32 v55, 0xffff0000, v95
    v_fma_f32 v54, v54, v40, v44
    v_fma_f32 v55, v55, v40, v44
    v_cvt_pk_bf16_f32 v95, v54, v55
    ds_write_b128 v18, v[92:95] offset:896
    s_branch K1_NOLN
K1_IDLE:
    s_cmp_lg_u32 s2, 9
    s_cbranch_scc1 K1_NOLN
    s_cmp_lg_u32 s20, 11
    s_cbranch_scc1 K1_NOLN
    s_load_dwordx2 s[4:5], s[0:1], 32
    s_waitcnt lgkmcnt(0)
    s_mov_b32 s52, s4
    s_mov_b32 s53, s5
    s_mov_b32 s54, 0x400
    s_mov_b32 s55, 0x00020000
    v_lshlrev_b32 v8, 4, v2
    buffer_load_dwordx4 v[12:15], v8, s[52:55], 0 offen
    s_mov_b32 s56, 0x3f803f80
    v_mov_b32 v18, s56
    v_mov_b32 v28, 0
    s_waitcnt vmcnt(0)
    v_dot2_f32_bf16 v28, v12, v18, v28
    v_dot2_f32_bf16 v28, v13, v18, v28
    v_dot2_f32_bf16 v28, v14, v18, v28
    v_dot2_f32_bf16 v28, v15, v18, v28
    s_nop 2
    v_add_f32_dpp v28, v28, v28 row_ror:8 row_mask:0xf bank_mask:0xf
    s_nop 1
    v_add_f32_dpp v28, v28, v28 row_ror:4 row_mask:0xf bank_mask:0xf
    s_nop 1
    v_add_f32_dpp v28, v28, v28 row_ror:2 row_mask:0xf bank_mask:0xf
    s_nop 1
    v_add_f32_dpp v28, v28, v28 row_ror:1 row_mask:0xf bank_mask:0xf
    s_nop 1
    v_readlane_b32 s56, v28, 0
    v_readlane_b32 s57, v28, 16
    v_readlane_b32 s58, v28, 32
    v_readlane_b32 s59, v28, 48
    s_nop 1
    v_mov_b32 v28, s56
    v_add_f32 v28, s57, v28
    v_add_f32 v28, s58, v28
    v_add_f32 v28, s59, v28
    v_mov_b32 v8, 0
    s_mov_b32 s37, 0xa08000
    buffer_store_dword v28, v8, s[24:27], s37 offen
K1_NOLN:
    s_and_b32 s39, s20, 1
    s_lshr_b32 s40, s20, 1
    v_and_b32 v19, 31, v2
    v_lshrrev_b32 v20, 5, v2
    s_lshl_b32 s31, s39, 5
    v_add_u32 v21, s31, v19
    v_mul_u32_u24 v21, 1040, v21
    v_lshl_add_u32 v21, v20, 4, v21
    v_add_u32 v21, 73728, v21
    v_bfe_u32 v22, v2, 2, 2
    v_and_b32 v23, 3, v2
    v_bfe_u32 v24, v2, 4, 1
    v_lshl_add_u32 v25, v20, 3, v22
    v_mul_u32_u24 v25, 384, v25
    v_lshl_add_u32 v25, v24, 5, v25
    v_lshl_add_u32 v25, v23, 3, v25
    v_lshrrev_b32 v26, 1, v22
    v_xor_b32 v27, s40, v26
    v_lshl_add_u32 v54, v27, 6, v25
    v_add_u32 v55, 49152, v54
    v_mov_b32 v96, 0
    v_mov_b32 v97, 0
    v_mov_b32 v98, 0
    v_mov_b32 v99, 0
    v_mov_b32 v100, 0
    v_mov_b32 v101, 0
    v_mov_b32 v102, 0
    v_mov_b32 v103, 0
    v_mov_b32 v104, 0
    v_mov_b32 v105, 0
    v_mov_b32 v106, 0
    v_mov_b32 v107, 0
    v_mov_b32 v108, 0
    v_mov_b32 v109, 0
    v_mov_b32 v110, 0
    v_mov_b32 v111, 0
    s_waitcnt lgkmcnt(0)
    s_waitcnt vmcnt(4)
    s_barrier
    ds_read_b128 v[112:115], v21 offset:0
    ds_read_b64_tr_b16 v[120:121], v54 offset:0
    ds_read_b64_tr_b16 v[122:123], v54 offset:1536
    ds_read_b128 v[116:119], v21 offset:32
    ds_read_b64_tr_b16 v[124:125], v54 offset:6144
    ds_read_b64_tr_b16 v[126:127], v54 offset:7680
    s_waitcnt lgkmcnt(3)
    v_mfma_f32_32x32x16_bf16 v[96:111], v[120:123], v[112:115], v[96:111]
    ds_read_b128 v[112:115], v21 offset:64
    ds_read_b64_tr_b16 v[120:121], v54 offset:12288
    ds_read_b64_tr_b16 v[122:123], v54 offset:13824
    s_waitcnt lgkmcnt(3)
    v_mfma_f32_32x32x16_bf16 v[96:111], v[124:127], v[116:119], v[96:111]
    ds_read_b128 v[116:119], v21 offset:96
    ds_read_b64_tr_b16 v[124:125], v54 offset:18432
    ds_read_b64_tr_b16 v[126:127], v54 offset:19968
    s_waitcnt lgkmcnt(3)
    v_mfma_f32_32x32x16_bf16 v[96:111], v[120:123], v[112:115], v[96:111]
    s_waitcnt lgkmcnt(0)
    v_mfma_f32_32x32x16_bf16 v[96:111], v[124:127], v[116:119], v[96:111]
    s_waitcnt vmcnt(2)
    s_barrier
    ds_read_b128 v[112:115], v21 offset:128
    ds_read_b64_tr_b16 v[120:121], v54 offset:24576
    ds_read_b64_tr_b16 v[122:123], v54 offset:26112
    s_mov_b32 s36, 589824
    s_add_u32 m0, s35, 0
    s_nop 0
    buffer_load_dwordx4 v10, s[16:19], s36 offen lds
    s_add_u32 m0, s35, 1024
    s_nop 0
    buffer_load_dwordx4 v11, s[16:19], s36 offen lds
    ds_read_b128 v[116:119], v21 offset:160
    ds_read_b64_tr_b16 v[124:125], v54 offset:30720
    ds_read_b64_tr_b16 v[126:127], v54 offset:32256
    s_waitcnt lgkmcnt(3)
    v_mfma_f32_32x32x16_bf16 v[96:111], v[120:123], v[112:115], v[96:111]
    ds_read_b128 v[112:115], v21 offset:192
    ds_read_b64_tr_b16 v[120:121], v54 offset:36864
    ds_read_b64_tr_b16 v[122:123], v54 offset:38400
    s_waitcnt lgkmcnt(3)
    v_mfma_f32_32x32x16_bf16 v[96:111], v[124:127], v[116:119], v[96:111]
    ds_read_b128 v[116:119], v21 offset:224
    ds_read_b64_tr_b16 v[124:125], v54 offset:43008
    ds_read_b64_tr_b16 v[126:127], v54 offset:44544
    s_waitcnt lgkmcnt(3)
    v_mfma_f32_32x32x16_bf16 v[96:111], v[120:123], v[112:115], v[96:111]
    s_waitcnt lgkmcnt(0)
    v_mfma_f32_32x32x16_bf16 v[96:111], v[124:127], v[116:119], v[96:111]
    s_waitcnt vmcnt(2)
    s_barrier
    ds_read_b128 v[112:115], v21 offset:256
    ds_read_b64_tr_b16 v[120:121], v55 offset:0
    ds_read_b64_tr_b16 v[122:123], v55 offset:1536
    s_mov_b32 s36, 786432
    s_add_u32 m0, s35, 24576
    s_nop 0
    buffer_load_dwordx4 v10, s[16:19], s36 offen lds
    s_add_u32 m0, s35, 25600
    s_nop 0
    buffer_load_dwordx4 v11, s[16:19], s36 offen lds
    ds_read_b128 v[116:119], v21 offset:288
    ds_read_b64_tr_b16 v[124:125], v55 offset:6144
    ds_read_b64_tr_b16 v[126:127], v55 offset:7680
    s_waitcnt lgkmcnt(3)
    v_mfma_f32_32x32x16_bf16 v[96:111], v[120:123], v[112:115], v[96:111]
    ds_read_b128 v[112:115], v21 offset:320
    ds_read_b64_tr_b16 v[120:121], v55 offset:12288
    ds_read_b64_tr_b16 v[122:123], v55 offset:13824
    s_waitcnt lgkmcnt(3)
    v_mfma_f32_32x32x16_bf16 v[96:111], v[124:127], v[116:119], v[96:111]
    ds_read_b128 v[116:119], v21 offset:352
    ds_read_b64_tr_b16 v[124:125], v55 offset:18432
    ds_read_b64_tr_b16 v[126:127], v55 offset:19968
    s_waitcnt lgkmcnt(3)
    v_mfma_f32_32x32x16_bf16 v[96:111], v[120:123], v[112:115], v[96:111]
    s_waitcnt lgkmcnt(0)
    v_mfma_f32_32x32x16_bf16 v[96:111], v[124:127], v[116:119], v[96:111]
    s_waitcnt vmcnt(2)
    s_barrier
    ds_read_b128 v[112:115], v21 offset:384
    ds_read_b64_tr_b16 v[120:121], v54 offset:0
    ds_read_b64_tr_b16 v[122:123], v54 offset:1536
    s_mov_b32 s36, 983040
    s_add_u32 m0, s35, 49152
    s_nop 0
    buffer_load_dwordx4 v10, s[16:19], s36 offen lds
    s_add_u32 m0, s35, 50176
    s_nop 0
    buffer_load_dwordx4 v11, s[16:19], s36 offen lds
    ds_read_b128 v[116:119], v21 offset:416
    ds_read_b64_tr_b16 v[124:125], v54 offset:6144
    ds_read_b64_tr_b16 v[126:127], v54 offset:7680
    s_waitcnt lgkmcnt(3)
    v_mfma_f32_32x32x16_bf16 v[96:111], v[120:123], v[112:115], v[96:111]
    ds_read_b128 v[112:115], v21 offset:448
    ds_read_b64_tr_b16 v[120:121], v54 offset:12288
    ds_read_b64_tr_b16 v[122:123], v54 offset:13824
    s_waitcnt lgkmcnt(3)
    v_mfma_f32_32x32x16_bf16 v[96:111], v[124:127], v[116:119], v[96:111]
    ds_read_b128 v[116:119], v21 offset:480
    ds_read_b64_tr_b16 v[124:125], v54 offset:18432
    ds_read_b64_tr_b16 v[126:127], v54 offset:19968
    s_waitcnt lgkmcnt(3)
    v_mfma_f32_32x32x16_bf16 v[96:111], v[120:123], v[112:115], v[96:111]
    s_waitcnt lgkmcnt(0)
    v_mfma_f32_32x32x16_bf16 v[96:111], v[124:127], v[116:119], v[96:111]
    s_waitcnt vmcnt(2)
    s_barrier
    ds_read_b128 v[112:115], v21 offset:512
    ds_read_b64_tr_b16 v[120:121], v54 offset:24576
    ds_read_b64_tr_b16 v[122:123], v54 offset:26112
    s_mov_b32 s36, 1179648
    s_add_u32 m0, s35, 0
    s_nop 0
    buffer_load_dwordx4 v10, s[16:19], s36 offen lds
    s_add_u32 m0, s35, 1024
    s_nop 0
    buffer_load_dwordx4 v11, s[16:19], s36 offen lds
    ds_read_b128 v[116:119], v21 offset:544
    ds_read_b64_tr_b16 v[124:125], v54 offset:30720
    ds_read_b64_tr_b16 v[126:127], v54 offset:32256
    s_waitcnt lgkmcnt(3)
    v_mfma_f32_32x32x16_bf16 v[96:111], v[120:123], v[112:115], v[96:111]
    ds_read_b128 v[112:115], v21 offset:576
    ds_read_b64_tr_b16 v[120:121], v54 offset:36864
    ds_read_b64_tr_b16 v[122:123], v54 offset:38400
    s_waitcnt lgkmcnt(3)
    v_mfma_f32_32x32x16_bf16 v[96:111], v[124:127], v[116:119], v[96:111]
    ds_read_b128 v[116:119], v21 offset:608
    ds_read_b64_tr_b16 v[124:125], v54 offset:43008
    ds_read_b64_tr_b16 v[126:127], v54 offset:44544
    s_waitcnt lgkmcnt(3)
    v_mfma_f32_32x32x16_bf16 v[96:111], v[120:123], v[112:115], v[96:111]
    s_waitcnt lgkmcnt(0)
    v_mfma_f32_32x32x16_bf16 v[96:111], v[124:127], v[116:119], v[96:111]
    s_waitcnt vmcnt(2)
    s_barrier
    ds_read_b128 v[112:115], v21 offset:640
    ds_read_b64_tr_b16 v[120:121], v55 offset:0
    ds_read_b64_tr_b16 v[122:123], v55 offset:1536
    s_mov_b32 s36, 1376256
    s_add_u32 m0, s35, 24576
    s_nop 0
    buffer_load_dwordx4 v10, s[16:19], s36 offen lds
    s_add_u32 m0, s35, 25600
    s_nop 0
    buffer_load_dwordx4 v11, s[16:19], s36 offen lds
    ds_read_b128 v[116:119], v21 offset:672
    ds_read_b64_tr_b16 v[124:125], v55 offset:6144
    ds_read_b64_tr_b16 v[126:127], v55 offset:7680
    s_waitcnt lgkmcnt(3)
    v_mfma_f32_32x32x16_bf16 v[96:111], v[120:123], v[112:115], v[96:111]
    ds_read_b128 v[112:115], v21 offset:704
    ds_read_b64_tr_b16 v[120:121], v55 offset:12288
    ds_read_b64_tr_b16 v[122:123], v55 offset:13824
    s_waitcnt lgkmcnt(3)
    v_mfma_f32_32x32x16_bf16 v[96:111], v[124:127], v[116:119], v[96:111]
    ds_read_b128 v[116:119], v21 offset:736
    ds_read_b64_tr_b16 v[124:125], v55 offset:18432
    ds_read_b64_tr_b16 v[126:127], v55 offset:19968
    s_waitcnt lgkmcnt(3)
    v_mfma_f32_32x32x16_bf16 v[96:111], v[120:123], v[112:115], v[96:111]
    s_waitcnt lgkmcnt(0)
    v_mfma_f32_32x32x16_bf16 v[96:111], v[124:127], v[116:119], v[96:111]
    s_waitcnt vmcnt(2)
    s_barrier
    ds_read_b128 v[112:115], v21 offset:768
    ds_read_b64_tr_b16 v[120:121], v54 offset:0
    ds_read_b64_tr_b16 v[122:123], v54 offset:1536
    ds_read_b128 v[116:119], v21 offset:800
    ds_read_b64_tr_b16 v[124:125], v54 offset:6144
    ds_read_b64_tr_b16 v[126:127], v54 offset:7680
    s_waitcnt lgkmcnt(3)
    v_mfma_f32_32x32x16_bf16 v[96:111], v[120:123], v[112:115], v[96:111]
    ds_read_b128 v[112:115], v21 offset:832
    ds_read_b64_tr_b16 v[120:121], v54 offset:12288
    ds_read_b64_tr_b16 v[122:123], v54 offset:13824
    s_waitcnt lgkmcnt(3)
    v_mfma_f32_32x32x16_bf16 v[96:111], v[124:127], v[116:119], v[96:111]
    ds_read_b128 v[116:119], v21 offset:864
    ds_read_b64_tr_b16 v[124:125], v54 offset:18432
    ds_read_b64_tr_b16 v[126:127], v54 offset:19968
    s_waitcnt lgkmcnt(3)
    v_mfma_f32_32x32x16_bf16 v[96:111], v[120:123], v[112:115], v[96:111]
    s_waitcnt lgkmcnt(0)
    v_mfma_f32_32x32x16_bf16 v[96:111], v[124:127], v[116:119], v[96:111]
    s_waitcnt vmcnt(0)
    s_barrier
    ds_read_b128 v[112:115], v21 offset:896
    ds_read_b64_tr_b16 v[120:121], v54 offset:24576
    ds_read_b64_tr_b16 v[122:123], v54 offset:26112
    ds_read_b128 v[116:119], v21 offset:928
    ds_read_b64_tr_b16 v[124:125], v54 offset:30720
    ds_read_b64_tr_b16 v[126:127], v54 offset:32256
    s_waitcnt lgkmcnt(3)
    v_mfma_f32_32x32x16_bf16 v[96:111], v[120:123], v[112:115], v[96:111]
    ds_read_b128 v[112:115], v21 offset:960
    ds_read_b64_tr_b16 v[120:121], v54 offset:36864
    ds_read_b64_tr_b16 v[122:123], v54 offset:38400
    s_waitcnt lgkmcnt(3)
    v_mfma_f32_32x32x16_bf16 v[96:111], v[124:127], v[116:119], v[96:111]
    ds_read_b128 v[116:119], v21 offset:992
    ds_read_b64_tr_b16 v[124:125], v54 offset:43008
    ds_read_b64_tr_b16 v[126:127], v54 offset:44544
    s_waitcnt lgkmcnt(3)
    v_mfma_f32_32x32x16_bf16 v[96:111], v[120:123], v[112:115], v[96:111]
    s_waitcnt lgkmcnt(0)
    v_mfma_f32_32x32x16_bf16 v[96:111], v[124:127], v[116:119], v[96:111]
    s_lshl_b32 s31, s21, 6
    s_lshl_b32 s42, s39, 5
    s_add_u32 s31, s31, s42
    v_add_u32 v22, s31, v19
    v_lshlrev_b32 v22, 5, v22
    v_lshl_add_u32 v22, v20, 4, v22
    s_mul_i32 s44, s22, 6
    s_add_u32 s44, s44, s40
    s_lshr_b32 s45, s44, 4
    s_and_b32 s46, s44, 15
    s_lshl_b32 s47, s45, 21
    s_lshl_b32 s46, s46, 17
    s_add_u32 s47, s47, s46
    s_add_u32 s48, s47, 0x10000
    s_cmp_eq_u32 s45, 0
    s_cselect_b32 s49, 0x3eb8aa3b, 1.0
    s_nop 7
    v_mul_f32 v96, s49, v96
    v_mul_f32 v97, s49, v97
    v_mul_f32 v98, s49, v98
    v_mul_f32 v99, s49, v99
    v_mul_f32 v100, s49, v100
    v_mul_f32 v101, s49, v101
    v_mul_f32 v102, s49, v102
    v_mul_f32 v103, s49, v103
    v_mul_f32 v104, s49, v104
    v_mul_f32 v105, s49, v105
    v_mul_f32 v106, s49, v106
    v_mul_f32 v107, s49, v107
    v_mul_f32 v108, s49, v108
    v_mul_f32 v109, s49, v109
    v_mul_f32 v110, s49, v110
    v_mul_f32 v111, s49, v111
    v_cvt_pk_bf16_f32 v96, v96, v97
    v_cvt_pk_bf16_f32 v97, v98, v99
    v_cvt_pk_bf16_f32 v98, v100, v101
    v_cvt_pk_bf16_f32 v99, v102, v103
    v_cvt_pk_bf16_f32 v100, v104, v105
    v_cvt_pk_bf16_f32 v101, v106, v107
    v_cvt_pk_bf16_f32 v102, v108, v109
    v_cvt_pk_bf16_f32 v103, v110, v111
    buffer_store_dwordx4 v[96:99], v22, s[24:27], s47 offen
    buffer_store_dwordx4 v[100:103], v22, s[24:27], s48 offen
    s_cmp_ge_u32 s2, 9
    s_cbranch_scc1 K1_NOZ
    s_cmp_ge_u32 s20, 4
    s_cbranch_scc1 K1_NOZ
    v_mov_b32 v20, 0
    v_mov_b32 v21, 0
    v_mov_b32 v22, 0
    v_mov_b32 v23, 0
    s_lshl_b32 s37, s2, 12
    s_cmp_eq_u32 s2, 8
    s_cselect_b32 s37, 0x10000, s37
    s_add_u32 s37, s37, 0xa00000
    v_lshlrev_b32 v24, 4, v0
    buffer_store_dwordx4 v[20:23], v24, s[24:27], s37 offen
K1_NOZ:
K1_END:
    s_endpgm
.globl k2_kernel
.p2align 8
.type k2_kernel,@function
k2_kernel:
    s_cmp_ge_u32 s2, 256
    s_cbranch_scc1 K2_END
    s_load_dwordx2 s[4:5], s[0:1], 80
    v_lshrrev_b32 v1, 6, v0
    v_and_b32 v2, 63, v0
    s_nop 0
    v_readfirstlane_b32 s20, v1
    s_and_b32 s21, s2, 7
    s_lshl_b32 s21, s21, 2
    s_bfe_u32 s22, s2, 0x20003
    s_add_u32 s21, s21, s22
    s_lshr_b32 s22, s2, 5
    s_and_b32 s31, s20, 7
    s_lshr_b32 s32, s20, 3
    s_waitcnt lgkmcnt(0)
    s_mov_b32 s8, s4
    s_mov_b32 s9, s5
    s_mov_b32 s10, 0x1000000
    s_mov_b32 s11, 0x00020000
    v_and_b32 v7, 31, v2
    v_lshrrev_b32 v6, 5, v2
    v_lshlrev_b32 v3, 5, v7
    v_lshl_add_u32 v3, v6, 4, v3
    v_lshlrev_b32 v4, 4, v2
    s_lshl_b32 s23, s21, 16
    s_lshl_b32 s24, s22, 13
    s_lshl_b32 s25, s31, 10
    s_add_u32 s24, s24, s25
    s_add_u32 s24, s24, s23
    buffer_load_dwordx4 v[8:11], v3, s[8:11], s24 offen
    s_lshl_b32 s33, s32, 15
    s_add_u32 s25, s25, s33
    s_add_u32 s26, s23, s25
    s_add_u32 s26, s26, 0x200000
    s_add_u32 s27, s26, 0
    s_add_u32 s28, s27, 0x200000
    s_add_u32 m0, s25, 0
    s_nop 0
    buffer_load_dwordx4 v4, s[8:11], s27 offen lds
    s_add_u32 m0, s25, 65536
    s_nop 0
    buffer_load_dwordx4 v4, s[8:11], s28 offen lds
    s_add_u32 s27, s26, 8192
    s_add_u32 s28, s27, 0x200000
    s_add_u32 m0, s25, 8192
    s_nop 0
    buffer_load_dwordx4 v4, s[8:11], s27 offen lds
    s_add_u32 m0, s25, 73728
    s_nop 0
    buffer_load_dwordx4 v4, s[8:11], s28 offen lds
    v_and_b32 v120, 1, v0
    v_mov_b32 v124, 0x3f80
    v_mov_b32 v125, 0
    v_mov_b32 v127, 0
    v_cmp_eq_u32 vcc, 0, v120
    s_nop 1
    v_cndmask_b32 v124, 0, v124, vcc
    v_mov_b32 v126, v124
    v_lshlrev_b32 v121, 4, v0
    v_add_u32 v121, 131072, v121
    s_cmp_ge_u32 s20, 9
    s_cbranch_scc1 K2_NOC
    ds_write_b128 v121, v[124:127]
K2_NOC:
    v_add_u32 v3, s33, v3
    v_bfe_u32 v120, v2, 2, 2
    v_and_b32 v121, 3, v2
    v_bfe_u32 v122, v2, 4, 1
    v_lshl_add_u32 v123, v6, 2, v120
    v_lshlrev_b32 v123, 5, v123
    v_lshl_add_u32 v123, v121, 3, v123
    v_add_u32 v123, 65536, v123
    v_add_u32 v123, s33, v123
    v_lshlrev_b32 v124, 5, v120
    v_lshl_add_u32 v124, v121, 3, v124
    v_add_u32 v124, 131072, v124
    v_cmp_eq_u32 vcc, 0, v122
    v_mov_b32 v125, 0x2000
    s_nop 1
    v_cndmask_b32 v5, v124, v123, vcc
    v_cndmask_b32 v1, 0, v125, vcc
    v_mov_b32 v64, 0
    v_mov_b32 v65, 0
    v_mov_b32 v66, 0
    v_mov_b32 v67, 0
    v_mov_b32 v68, 0
    v_mov_b32 v69, 0
    v_mov_b32 v70, 0
    v_mov_b32 v71, 0
    v_mov_b32 v72, 0
    v_mov_b32 v73, 0
    v_mov_b32 v74, 0
    v_mov_b32 v75, 0
    v_mov_b32 v76, 0
    v_mov_b32 v77, 0
    v_mov_b32 v78, 0
    v_mov_b32 v79, 0
    v_mov_b32 v112, 0
    v_mov_b32 v104, 0
    v_mov_b32 v113, 0
    v_mov_b32 v105, 0
    v_mov_b32 v114, 0
    v_mov_b32 v106, 0
    v_mov_b32 v115, 0
    v_mov_b32 v107, 0
    v_mov_b32 v116, 0
    v_mov_b32 v108, 0
    v_mov_b32 v117, 0
    v_mov_b32 v109, 0
    v_mov_b32 v118, 0
    v_mov_b32 v110, 0
    v_mov_b32 v119, 0
    v_mov_b32 v111, 0
    s_waitcnt vmcnt(2) lgkmcnt(0)
    s_barrier
    ds_read_b128 v[88:91], v3
    s_waitcnt lgkmcnt(0)
    v_mfma_f32_32x32x16_bf16 v[32:47], v[88:91], v[8:11], 0
    ds_read_b128 v[92:95], v3 offset:1024
    ds_read_b64_tr_b16 v[96:97], v5 offset:0
    ds_read_b64_tr_b16 v[98:99], v5 offset:256
    ds_read_b64_tr_b16 v[100:101], v5 offset:512
    ds_read_b64_tr_b16 v[102:103], v5 offset:768
    s_add_u32 s27, s26, 16384
    s_add_u32 s28, s27, 0x200000
    s_add_u32 m0, s25, 16384
    s_nop 0
    buffer_load_dwordx4 v4, s[8:11], s27 offen lds
    s_add_u32 m0, s25, 81920
    s_nop 0
    buffer_load_dwordx4 v4, s[8:11], s28 offen lds
    s_add_u32 s27, s26, 24576
    s_add_u32 s28, s27, 0x200000
    s_add_u32 m0, s25, 24576
    s_nop 0
    buffer_load_dwordx4 v4, s[8:11], s27 offen lds
    s_add_u32 m0, s25, 90112
    s_nop 0
    buffer_load_dwordx4 v4, s[8:11], s28 offen lds
    v_max3_f32 v120, v32, v33, v34
    v_max3_f32 v120, v120, v35, v36
    v_max3_f32 v120, v120, v37, v38
    v_max3_f32 v120, v120, v39, v40
    v_max3_f32 v120, v120, v41, v42
    v_max3_f32 v120, v120, v43, v44
    v_max3_f32 v120, v120, v45, v46
    v_max_f32 v120, v120, v47
    v_mov_b32 v121, v120
    s_nop 1
    v_permlane32_swap_b32 v120, v121
    s_nop 1
    v_max_f32 v120, v120, v121
    v_sub_f32 v120, 0, v120
    v_mov_b32 v16, v120
    v_mov_b32 v17, v120
    v_mov_b32 v18, v120
    v_mov_b32 v19, v120
    v_mov_b32 v20, v120
    v_mov_b32 v21, v120
    v_mov_b32 v22, v120
    v_mov_b32 v23, v120
    v_mov_b32 v24, v120
    v_mov_b32 v25, v120
    v_mov_b32 v26, v120
    v_mov_b32 v27, v120
    v_mov_b32 v28, v120
    v_mov_b32 v29, v120
    v_mov_b32 v30, v120
    v_mov_b32 v31, v120
    s_nop 1
    v_mfma_f32_32x32x16_bf16 v[32:47], v[88:91], v[8:11], v[16:31]
    s_mov_b32 s30, 0
    s_nop 9
K2_LOOP:
    s_waitcnt lgkmcnt(4)
    v_mfma_f32_32x32x16_bf16 v[48:63], v[92:95], v[8:11], v[16:31]
    ds_read_b128 v[88:91], v3 offset:2048
    v_exp_f32 v32, v32
    v_exp_f32 v33, v33
    v_exp_f32 v34, v34
    v_cvt_pk_bf16_f32 v80, v32, v33
    v_exp_f32 v35, v35
    v_exp_f32 v36, v36
    v_cvt_pk_bf16_f32 v81, v34, v35
    v_mfma_f32_32x32x16_bf16 v[64:79], v[104:107], v[112:115], v[64:79]
    v_exp_f32 v37, v37
    v_exp_f32 v38, v38
    v_cvt_pk_bf16_f32 v82, v36, v37
    v_exp_f32 v39, v39
    v_exp_f32 v40, v40
    v_cvt_pk_bf16_f32 v83, v38, v39
    v_exp_f32 v41, v41
    v_exp_f32 v42, v42
    v_cvt_pk_bf16_f32 v84, v40, v41
    v_mfma_f32_32x32x16_bf16 v[64:79], v[108:111], v[116:119], v[64:79]
    ds_read_b64_tr_b16 v[104:105], v5 offset:1024
    ds_read_b64_tr_b16 v[106:107], v5 offset:1280
    ds_read_b64_tr_b16 v[108:109], v5 offset:1536
    ds_read_b64_tr_b16 v[110:111], v5 offset:1792
    v_exp_f32 v43, v43
    v_exp_f32 v44, v44
    v_cvt_pk_bf16_f32 v85, v42, v43
    v_exp_f32 v45, v45
    v_exp_f32 v46, v46
    v_cvt_pk_bf16_f32 v86, v44, v45
    v_exp_f32 v47, v47
    s_nop 0
    v_cvt_pk_bf16_f32 v87, v46, v47
    s_waitcnt lgkmcnt(4)
    v_mfma_f32_32x32x16_bf16 v[32:47], v[88:91], v[8:11], v[16:31]
    ds_read_b128 v[92:95], v3 offset:3072
    v_exp_f32 v48, v48
    v_exp_f32 v49, v49
    v_exp_f32 v50, v50
    v_cvt_pk_bf16_f32 v112, v48, v49
    v_exp_f32 v51, v51
    v_exp_f32 v52, v52
    v_cvt_pk_bf16_f32 v113, v50, v51
    v_mfma_f32_32x32x16_bf16 v[64:79], v[96:99], v[80:83], v[64:79]
    v_exp_f32 v53, v53
    v_exp_f32 v54, v54
    v_cvt_pk_bf16_f32 v114, v52, v53
    v_exp_f32 v55, v55
    v_exp_f32 v56, v56
    v_cvt_pk_bf16_f32 v115, v54, v55
    v_exp_f32 v57, v57
    v_exp_f32 v58, v58
    v_cvt_pk_bf16_f32 v116, v56, v57
    v_mfma_f32_32x32x16_bf16 v[64:79], v[100:103], v[84:87], v[64:79]
    ds_read_b64_tr_b16 v[96:97], v5 offset:2048
    ds_read_b64_tr_b16 v[98:99], v5 offset:2304
    ds_read_b64_tr_b16 v[100:101], v5 offset:2560
    ds_read_b64_tr_b16 v[102:103], v5 offset:2816
    v_exp_f32 v59, v59
    v_exp_f32 v60, v60
    v_cvt_pk_bf16_f32 v117, v58, v59
    v_exp_f32 v61, v61
    v_exp_f32 v62, v62
    v_cvt_pk_bf16_f32 v118, v60, v61
    v_exp_f32 v63, v63
    s_nop 0
    v_cvt_pk_bf16_f32 v119, v62, v63
    s_waitcnt lgkmcnt(4)
    v_mfma_f32_32x32x16_bf16 v[48:63], v[92:95], v[8:11], v[16:31]
    ds_read_b128 v[88:91], v3 offset:4096
    v_exp_f32 v32, v32
    v_exp_f32 v33, v33
    v_exp_f32 v34, v34
    v_cvt_pk_bf16_f32 v80, v32, v33
    v_exp_f32 v35, v35
    v_exp_f32 v36, v36
    v_cvt_pk_bf16_f32 v81, v34, v35
    v_mfma_f32_32x32x16_bf16 v[64:79], v[104:107], v[112:115], v[64:79]
    v_exp_f32 v37, v37
    v_exp_f32 v38, v38
    v_cvt_pk_bf16_f32 v82, v36, v37
    v_exp_f32 v39, v39
    v_exp_f32 v40, v40
    v_cvt_pk_bf16_f32 v83, v38, v39
    v_exp_f32 v41, v41
    v_exp_f32 v42, v42
    v_cvt_pk_bf16_f32 v84, v40, v41
    v_mfma_f32_32x32x16_bf16 v[64:79], v[108:111], v[116:119], v[64:79]
    ds_read_b64_tr_b16 v[104:105], v5 offset:3072
    ds_read_b64_tr_b16 v[106:107], v5 offset:3328
    ds_read_b64_tr_b16 v[108:109], v5 offset:3584
    ds_read_b64_tr_b16 v[110:111], v5 offset:3840
    v_exp_f32 v43, v43
    v_exp_f32 v44, v44
    v_cvt_pk_bf16_f32 v85, v42, v43
    v_exp_f32 v45, v45
    v_exp_f32 v46, v46
    v_cvt_pk_bf16_f32 v86, v44, v45
    v_exp_f32 v47, v47
    s_nop 0
    v_cvt_pk_bf16_f32 v87, v46, v47
    s_waitcnt lgkmcnt(4)
    v_mfma_f32_32x32x16_bf16 v[32:47], v[88:91], v[8:11], v[16:31]
    ds_read_b128 v[92:95], v3 offset:5120
    v_exp_f32 v48, v48
    v_exp_f32 v49, v49
    v_exp_f32 v50, v50
    v_cvt_pk_bf16_f32 v112, v48, v49
    v_exp_f32 v51, v51
    v_exp_f32 v52, v52
    v_cvt_pk_bf16_f32 v113, v50, v51
    v_mfma_f32_32x32x16_bf16 v[64:79], v[96:99], v[80:83], v[64:79]
    v_exp_f32 v53, v53
    v_exp_f32 v54, v54
    v_cvt_pk_bf16_f32 v114, v52, v53
    v_exp_f32 v55, v55
    v_exp_f32 v56, v56
    v_cvt_pk_bf16_f32 v115, v54, v55
    v_exp_f32 v57, v57
    v_exp_f32 v58, v58
    v_cvt_pk_bf16_f32 v116, v56, v57
    v_mfma_f32_32x32x16_bf16 v[64:79], v[100:103], v[84:87], v[64:79]
    ds_read_b64_tr_b16 v[96:97], v5 offset:4096
    ds_read_b64_tr_b16 v[98:99], v5 offset:4352
    ds_read_b64_tr_b16 v[100:101], v5 offset:4608
    ds_read_b64_tr_b16 v[102:103], v5 offset:4864
    v_exp_f32 v59, v59
    v_exp_f32 v60, v60
    v_cvt_pk_bf16_f32 v117, v58, v59
    v_exp_f32 v61, v61
    v_exp_f32 v62, v62
    v_cvt_pk_bf16_f32 v118, v60, v61
    v_exp_f32 v63, v63
    s_nop 0
    v_cvt_pk_bf16_f32 v119, v62, v63
    s_waitcnt lgkmcnt(4)
    v_mfma_f32_32x32x16_bf16 v[48:63], v[92:95], v[8:11], v[16:31]
    ds_read_b128 v[88:91], v3 offset:6144
    v_exp_f32 v32, v32
    v_exp_f32 v33, v33
    v_exp_f32 v34, v34
    v_cvt_pk_bf16_f32 v80, v32, v33
    v_exp_f32 v35, v35
    v_exp_f32 v36, v36
    v_cvt_pk_bf16_f32 v81, v34, v35
    v_mfma_f32_32x32x16_bf16 v[64:79], v[104:107], v[112:115], v[64:79]
    v_exp_f32 v37, v37
    v_exp_f32 v38, v38
    v_cvt_pk_bf16_f32 v82, v36, v37
    v_exp_f32 v39, v39
    v_exp_f32 v40, v40
    v_cvt_pk_bf16_f32 v83, v38, v39
    v_exp_f32 v41, v41
    v_exp_f32 v42, v42
    v_cvt_pk_bf16_f32 v84, v40, v41
    v_mfma_f32_32x32x16_bf16 v[64:79], v[108:111], v[116:119], v[64:79]
    ds_read_b64_tr_b16 v[104:105], v5 offset:5120
    ds_read_b64_tr_b16 v[106:107], v5 offset:5376
    ds_read_b64_tr_b16 v[108:109], v5 offset:5632
    ds_read_b64_tr_b16 v[110:111], v5 offset:5888
    v_exp_f32 v43, v43
    v_exp_f32 v44, v44
    v_cvt_pk_bf16_f32 v85, v42, v43
    v_exp_f32 v45, v45
    v_exp_f32 v46, v46
    v_cvt_pk_bf16_f32 v86, v44, v45
    v_exp_f32 v47, v47
    s_nop 0
    v_cvt_pk_bf16_f32 v87, v46, v47
    s_cmp_gt_u32 s30, 2
    s_cbranch_scc1 K2_NW
    s_cmp_eq_u32 s30, 0
    s_cbranch_scc0 K2_W1
    s_waitcnt vmcnt(4)
    s_branch K2_WB
K2_W1:
    s_cmp_eq_u32 s30, 1
    s_cbranch_scc0 K2_W2
    s_waitcnt vmcnt(2)
    s_branch K2_WB
K2_W2:
    s_waitcnt vmcnt(0)
    s_load_dwordx2 s[40:41], s[0:1], 16
    s_load_dwordx4 s[44:47], s[0:1], 40
    s_load_dwordx2 s[48:49], s[0:1], 56
    s_lshl_b32 s42, s2, 4
    s_add_u32 s42, s42, s20
    s_waitcnt lgkmcnt(0)
    s_cmp_lt_u32 s42, 1792
    s_cselect_b32 s52, s44, s46
    s_cselect_b32 s53, s45, s47
    s_cselect_b32 s43, 0, 1792
    s_cmp_lt_u32 s42, 3584
    s_cselect_b32 s52, s52, s48
    s_cselect_b32 s53, s53, s49
    s_cselect_b32 s43, s43, 3584
    s_mov_b32 s54, 1835008
    s_mov_b32 s55, 0x00020000
    s_sub_u32 s43, s42, s43
    s_lshl_b32 s43, s43, 10
    buffer_load_dwordx4 v[12:15], v4, s[52:55], s43 offen
    s_add_u32 s43, s42, 512
    s_sub_u32 s50, s42, 1280
    s_mov_b32 s51, 524288
    s_cmp_lt_u32 s42, 1280
    s_cselect_b32 s56, s48, s40
    s_cselect_b32 s57, s49, s41
    s_cselect_b32 s58, s54, s51
    s_cselect_b32 s43, s43, s50
    s_mov_b32 s59, 0x00020000
    s_lshl_b32 s43, s43, 10
    buffer_load_dwordx4 v[12:15], v4, s[56:59], s43 offen
K2_WB:
    s_barrier
K2_NW:
    s_waitcnt lgkmcnt(4)
    v_mfma_f32_32x32x16_bf16 v[32:47], v[88:91], v[8:11], v[16:31]
    ds_read_b128 v[92:95], v3 offset:7168
    v_exp_f32 v48, v48
    v_exp_f32 v49, v49
    v_exp_f32 v50, v50
    v_cvt_pk_bf16_f32 v112, v48, v49
    v_exp_f32 v51, v51
    v_exp_f32 v52, v52
    v_cvt_pk_bf16_f32 v113, v50, v51
    v_mfma_f32_32x32x16_bf16 v[64:79], v[96:99], v[80:83], v[64:79]
    v_exp_f32 v53, v53
    v_exp_f32 v54, v54
    v_cvt_pk_bf16_f32 v114, v52, v53
    v_exp_f32 v55, v55
    v_exp_f32 v56, v56
    v_cvt_pk_bf16_f32 v115, v54, v55
    v_exp_f32 v57, v57
    v_exp_f32 v58, v58
    v_cvt_pk_bf16_f32 v116, v56, v57
    v_mfma_f32_32x32x16_bf16 v[64:79], v[100:103], v[84:87], v[64:79]
    ds_read_b64_tr_b16 v[96:97], v5 offset:6144
    ds_read_b64_tr_b16 v[98:99], v5 offset:6400
    ds_read_b64_tr_b16 v[100:101], v5 offset:6656
    ds_read_b64_tr_b16 v[102:103], v5 offset:6912
    v_exp_f32 v59, v59
    v_exp_f32 v60, v60
    v_cvt_pk_bf16_f32 v117, v58, v59
    v_exp_f32 v61, v61
    v_exp_f32 v62, v62
    v_cvt_pk_bf16_f32 v118, v60, v61
    v_exp_f32 v63, v63
    s_nop 0
    v_cvt_pk_bf16_f32 v119, v62, v63
    s_waitcnt lgkmcnt(4)
    v_mfma_f32_32x32x16_bf16 v[48:63], v[92:95], v[8:11], v[16:31]
    ds_read_b128 v[88:91], v3 offset:8192
    v_exp_f32 v32, v32
    v_exp_f32 v33, v33
    v_exp_f32 v34, v34
    v_cvt_pk_bf16_f32 v80, v32, v33
    v_exp_f32 v35, v35
    v_exp_f32 v36, v36
    v_cvt_pk_bf16_f32 v81, v34, v35
    v_mfma_f32_32x32x16_bf16 v[64:79], v[104:107], v[112:115], v[64:79]
    v_exp_f32 v37, v37
    v_exp_f32 v38, v38
    v_cvt_pk_bf16_f32 v82, v36, v37
    v_exp_f32 v39, v39
    v_exp_f32 v40, v40
    v_cvt_pk_bf16_f32 v83, v38, v39
    v_exp_f32 v41, v41
    v_exp_f32 v42, v42
    v_cvt_pk_bf16_f32 v84, v40, v41
    v_mfma_f32_32x32x16_bf16 v[64:79], v[108:111], v[116:119], v[64:79]
    ds_read_b64_tr_b16 v[104:105], v5 offset:7168
    ds_read_b64_tr_b16 v[106:107], v5 offset:7424
    ds_read_b64_tr_b16 v[108:109], v5 offset:7680
    ds_read_b64_tr_b16 v[110:111], v5 offset:7936
    v_exp_f32 v43, v43
    v_exp_f32 v44, v44
    v_cvt_pk_bf16_f32 v85, v42, v43
    v_exp_f32 v45, v45
    v_exp_f32 v46, v46
    v_cvt_pk_bf16_f32 v86, v44, v45
    v_exp_f32 v47, v47
    s_nop 0
    v_cvt_pk_bf16_f32 v87, v46, v47
    s_waitcnt lgkmcnt(4)
    v_mfma_f32_32x32x16_bf16 v[32:47], v[88:91], v[8:11], v[16:31]
    ds_read_b128 v[92:95], v3 offset:9216
    v_exp_f32 v48, v48
    v_exp_f32 v49, v49
    v_exp_f32 v50, v50
    v_cvt_pk_bf16_f32 v112, v48, v49
    v_exp_f32 v51, v51
    v_exp_f32 v52, v52
    v_cvt_pk_bf16_f32 v113, v50, v51
    v_mfma_f32_32x32x16_bf16 v[64:79], v[96:99], v[80:83], v[64:79]
    v_exp_f32 v53, v53
    v_exp_f32 v54, v54
    v_cvt_pk_bf16_f32 v114, v52, v53
    v_exp_f32 v55, v55
    v_exp_f32 v56, v56
    v_cvt_pk_bf16_f32 v115, v54, v55
    v_exp_f32 v57, v57
    v_exp_f32 v58, v58
    v_cvt_pk_bf16_f32 v116, v56, v57
    v_mfma_f32_32x32x16_bf16 v[64:79], v[100:103], v[84:87], v[64:79]
    ds_read_b64_tr_b16 v[96:97], v5 offset:8192
    ds_read_b64_tr_b16 v[98:99], v5 offset:8448
    ds_read_b64_tr_b16 v[100:101], v5 offset:8704
    ds_read_b64_tr_b16 v[102:103], v5 offset:8960
    v_exp_f32 v59, v59
    v_exp_f32 v60, v60
    v_cvt_pk_bf16_f32 v117, v58, v59
    v_exp_f32 v61, v61
    v_exp_f32 v62, v62
    v_cvt_pk_bf16_f32 v118, v60, v61
    v_exp_f32 v63, v63
    s_nop 0
    v_cvt_pk_bf16_f32 v119, v62, v63
    v_add_u32 v3, 0x2000, v3
    v_add_u32 v5, v5, v1
    s_add_u32 s30, s30, 1
    s_cmp_lt_u32 s30, 4
    s_cbranch_scc1 K2_LOOP
    s_waitcnt lgkmcnt(0)
    v_mfma_f32_32x32x16_bf16 v[64:79], v[104:107], v[112:115], v[64:79]
    v_mfma_f32_32x32x16_bf16 v[64:79], v[108:111], v[116:119], v[64:79]
    s_nop 15
    v_mov_b32 v120, 0x5d800000
    v_cmp_nlt_f32 vcc, v72, v120
    s_nop 4
    s_cbranch_vccnz K2_SLOW
K2_OUT:
    s_mul_i32 s34, s31, 2560
    s_add_u32 s34, s34, 140288
    v_lshl_add_u32 v121, v2, 2, s34
    s_cmp_eq_u32 s32, 0
    s_cbranch_scc1 K2_LOW
    ds_write_b32 v121, v64 offset:0
    ds_write_b32 v121, v65 offset:256
    ds_write_b32 v121, v66 offset:512
    ds_write_b32 v121, v67 offset:768
    ds_write_b32 v121, v68 offset:1024
    ds_write_b32 v121, v69 offset:1280
    ds_write_b32 v121, v70 offset:1536
    ds_write_b32 v121, v71 offset:1792
    ds_write_b32 v121, v72 offset:2048
    ds_write_b32 v121, v16 offset:2304
    s_waitcnt lgkmcnt(0)
    s_barrier
    s_endpgm
K2_LOW:
    s_barrier
    ds_read_b32 v32, v121 offset:0
    ds_read_b32 v33, v121 offset:256
    ds_read_b32 v34, v121 offset:512
    ds_read_b32 v35, v121 offset:768
    ds_read_b32 v36, v121 offset:1024
    ds_read_b32 v37, v121 offset:1280
    ds_read_b32 v38, v121 offset:1536
    ds_read_b32 v39, v121 offset:1792
    ds_read_b32 v40, v121 offset:2048
    ds_read_b32 v41, v121 offset:2304
    s_waitcnt lgkmcnt(0)
    v_min_f32 v120, v16, v41
    v_sub_f32 v122, v120, v16
    v_sub_f32 v123, v120, v41
    v_exp_f32 v122, v122
    v_exp_f32 v123, v123
    s_nop 0
    v_mul_f32 v64, v64, v122
    v_fmac_f32 v64, v32, v123
    v_mul_f32 v65, v65, v122
    v_fmac_f32 v65, v33, v123
    v_mul_f32 v66, v66, v122
    v_fmac_f32 v66, v34, v123
    v_mul_f32 v67, v67, v122
    v_fmac_f32 v67, v35, v123
    v_mul_f32 v68, v68, v122
    v_fmac_f32 v68, v36, v123
    v_mul_f32 v69, v69, v122
    v_fmac_f32 v69, v37, v123
    v_mul_f32 v70, v70, v122
    v_fmac_f32 v70, v38, v123
    v_mul_f32 v71, v71, v122
    v_fmac_f32 v71, v39, v123
    v_mul_f32 v72, v72, v122
    v_fmac_f32 v72, v40, v123
    v_rcp_f32 v120, v72
    s_nop 0
    v_mul_f32 v64, v64, v120
    v_mul_f32 v65, v65, v120
    v_mul_f32 v66, v66, v120
    v_mul_f32 v67, v67, v120
    v_mul_f32 v68, v68, v120
    v_mul_f32 v69, v69, v120
    v_mul_f32 v70, v70, v120
    v_mul_f32 v71, v71, v120
    v_cvt_pk_bf16_f32 v80, v64, v65
    v_cvt_pk_bf16_f32 v81, v66, v67
    v_cvt_pk_bf16_f32 v82, v68, v69
    v_cvt_pk_bf16_f32 v83, v70, v71
    s_lshl_b32 s24, s22, 8
    s_lshl_b32 s25, s31, 5
    s_add_u32 s24, s24, s25
    v_add_u32 v121, s24, v7
    v_lshlrev_b32 v121, 10, v121
    v_lshl_add_u32 v121, v6, 4, v121
    s_lshl_b32 s25, s21, 5
    s_add_u32 s25, s25, 0x600000
    buffer_store_dwordx4 v[80:83], v121, s[8:11], s25 offen
    s_endpgm
K2_SLOW:
    v_subrev_u32 v3, 0x8000, v3
    v_lshlrev_b32 v125, 2, v1
    v_sub_u32 v5, v5, v125
    v_lshrrev_b32 v1, 3, v1
    v_sub_f32 v16, 0, v16
    v_mov_b32 v64, 0
    v_mov_b32 v65, 0
    v_mov_b32 v66, 0
    v_mov_b32 v67, 0
    v_mov_b32 v68, 0
    v_mov_b32 v69, 0
    v_mov_b32 v70, 0
    v_mov_b32 v71, 0
    v_mov_b32 v72, 0
    v_mov_b32 v73, 0
    v_mov_b32 v74, 0
    v_mov_b32 v75, 0
    v_mov_b32 v76, 0
    v_mov_b32 v77, 0
    v_mov_b32 v78, 0
    v_mov_b32 v79, 0
    s_mov_b32 s30, 0
K2_SL:
    ds_read_b128 v[88:91], v3
    ds_read_b64_tr_b16 v[96:97], v5 offset:0
    ds_read_b64_tr_b16 v[98:99], v5 offset:256
    ds_read_b64_tr_b16 v[100:101], v5 offset:512
    ds_read_b64_tr_b16 v[102:103], v5 offset:768
    s_waitcnt lgkmcnt(0)
    v_mfma_f32_32x32x16_bf16 v[32:47], v[88:91], v[8:11], 0
    s_nop 15
    v_max3_f32 v120, v32, v33, v34
    v_max3_f32 v120, v120, v35, v36
    v_max3_f32 v120, v120, v37, v38
    v_max3_f32 v120, v120, v39, v40
    v_max3_f32 v120, v120, v41, v42
    v_max3_f32 v120, v120, v43, v44
    v_max3_f32 v120, v120, v45, v46
    v_max3_f32 v120, v120, v47, v16
    v_mov_b32 v121, v120
    s_nop 1
    v_permlane32_swap_b32 v120, v121
    s_nop 1
    v_max_f32 v120, v120, v121
    v_sub_f32 v121, v16, v120
    v_exp_f32 v121, v121
    v_mov_b32 v16, v120
    v_mul_f32 v64, v64, v121
    v_mul_f32 v65, v65, v121
    v_mul_f32 v66, v66, v121
    v_mul_f32 v67, v67, v121
    v_mul_f32 v68, v68, v121
    v_mul_f32 v69, v69, v121
    v_mul_f32 v70, v70, v121
    v_mul_f32 v71, v71, v121
    v_mul_f32 v72, v72, v121
    v_mul_f32 v73, v73, v121
    v_mul_f32 v74, v74, v121
    v_mul_f32 v75, v75, v121
    v_mul_f32 v76, v76, v121
    v_mul_f32 v77, v77, v121
    v_mul_f32 v78, v78, v121
    v_mul_f32 v79, v79, v121
    v_sub_f32 v32, v32, v120
    v_sub_f32 v33, v33, v120
    v_sub_f32 v34, v34, v120
    v_sub_f32 v35, v35, v120
    v_sub_f32 v36, v36, v120
    v_sub_f32 v37, v37, v120
    v_sub_f32 v38, v38, v120
    v_sub_f32 v39, v39, v120
    v_sub_f32 v40, v40, v120
    v_sub_f32 v41, v41, v120
    v_sub_f32 v42, v42, v120
    v_sub_f32 v43, v43, v120
    v_sub_f32 v44, v44, v120
    v_sub_f32 v45, v45, v120
    v_sub_f32 v46, v46, v120
    v_sub_f32 v47, v47, v120
    v_exp_f32 v32, v32
    v_exp_f32 v33, v33
    v_exp_f32 v34, v34
    v_exp_f32 v35, v35
    v_exp_f32 v36, v36
    v_exp_f32 v37, v37
    v_exp_f32 v38, v38
    v_exp_f32 v39, v39
    v_exp_f32 v40, v40
    v_exp_f32 v41, v41
    v_exp_f32 v42, v42
    v_exp_f32 v43, v43
    v_exp_f32 v44, v44
    v_exp_f32 v45, v45
    v_exp_f32 v46, v46
    v_exp_f32 v47, v47
    s_nop 0
    v_cvt_pk_bf16_f32 v80, v32, v33
    v_cvt_pk_bf16_f32 v81, v34, v35
    v_cvt_pk_bf16_f32 v82, v36, v37
    v_cvt_pk_bf16_f32 v83, v38, v39
    v_cvt_pk_bf16_f32 v84, v40, v41
    v_cvt_pk_bf16_f32 v85, v42, v43
    v_cvt_pk_bf16_f32 v86, v44, v45
    v_cvt_pk_bf16_f32 v87, v46, v47
    s_nop 1
    v_mfma_f32_32x32x16_bf16 v[64:79], v[96:99], v[80:83], v[64:79]
    v_mfma_f32_32x32x16_bf16 v[64:79], v[100:103], v[84:87], v[64:79]
    v_add_u32 v3, 0x400, v3
    v_add_u32 v5, v5, v1
    s_nop 15
    s_add_u32 s30, s30, 1
    s_cmp_lt_u32 s30, 32
    s_cbranch_scc1 K2_SL
    v_sub_f32 v16, 0, v16
    s_branch K2_OUT
K2_END:
    s_endpgm
.globl k3_kernel
.p2align 8
.type k3_kernel,@function
k3_kernel:
    s_cmp_ge_u32 s2, 256
    s_cbranch_scc1 K3_END
    s_load_dwordx2 s[4:5], s[0:1], 0
    s_load_dwordx2 s[6:7], s[0:1], 16
    s_load_dwordx2 s[8:9], s[0:1], 80
    s_load_dwordx2 s[10:11], s[0:1], 32
    v_lshrrev_b32 v1, 6, v0
    v_and_b32 v2, 63, v0
    s_nop 0
    v_readfirstlane_b32 s20, v1
    s_and_b32 s21, s2, 7
    s_lshl_b32 s21, s21, 2
    s_bfe_u32 s22, s2, 0x20003
    s_add_u32 s21, s21, s22
    s_lshr_b32 s22, s2, 5
    s_and_b32 s39, s20, 1
    s_lshr_b32 s40, s20, 1
    s_waitcnt lgkmcnt(0)
    s_mov_b32 s12, s4
    s_mov_b32 s13, s5
    s_mov_b32 s14, 0x200000
    s_mov_b32 s15, 0x00020000
    s_mov_b32 s16, s6
    s_mov_b32 s17, s7
    s_mov_b32 s18, 0x80000
    s_mov_b32 s19, 0x00020000
    s_mov_b32 s24, s8
    s_mov_b32 s25, s9
    s_mov_b32 s26, 0x1000000
    s_mov_b32 s27, 0x00020000
    s_mov_b32 s44, s10
    s_mov_b32 s45, s11
    s_mov_b32 s46, 0x400
    s_mov_b32 s47, 0x00020000
    v_lshrrev_b32 v4, 3, v2
    v_lshlrev_b32 v4, 10, v4
    v_bfe_u32 v5, v2, 2, 1
    v_bfe_u32 v6, v2, 4, 1
    v_xor_b32 v5, v5, v6
    v_lshl_add_u32 v4, v5, 6, v4
    v_and_b32 v5, 3, v2
    v_lshl_add_u32 v4, v5, 4, v4
    s_lshl_b32 s31, s22, 7
    v_add_u32 v4, s31, v4
    v_lshlrev_b32 v3, 4, v2
    s_lshl_b32 s32, s20, 17
    s_lshl_b32 s33, s20, 14
    s_lshl_b32 s35, s21, 16
    s_lshl_b32 s36, s20, 14
    s_add_u32 s35, s35, s36
    s_add_u32 s35, s35, 0x600000
    s_mul_i32 s36, s20, 16640
    s_add_u32 s36, s36, 65536
    s_add_u32 s34, s35, 0
    s_add_u32 m0, s36, 0
    s_nop 0
    buffer_load_dwordx4 v3, s[24:27], s34 offen lds
    s_add_u32 s34, s32, 0
    s_add_u32 m0, s33, 0
    s_nop 0
    buffer_load_dwordx4 v4, s[16:19], s34 offen lds
    s_add_u32 s34, s35, 1024
    s_add_u32 m0, s36, 1040
    s_nop 0
    buffer_load_dwordx4 v3, s[24:27], s34 offen lds
    s_add_u32 s34, s32, 8192
    s_add_u32 m0, s33, 1024
    s_nop 0
    buffer_load_dwordx4 v4, s[16:19], s34 offen lds
    s_add_u32 s34, s35, 2048
    s_add_u32 m0, s36, 2080
    s_nop 0
    buffer_load_dwordx4 v3, s[24:27], s34 offen lds
    s_add_u32 s34, s32, 16384
    s_add_u32 m0, s33, 2048
    s_nop 0
    buffer_load_dwordx4 v4, s[16:19], s34 offen lds
    s_add_u32 s34, s35, 3072
    s_add_u32 m0, s36, 3120
    s_nop 0
    buffer_load_dwordx4 v3, s[24:27], s34 offen lds
    s_add_u32 s34, s32, 24576
    s_add_u32 m0, s33, 3072
    s_nop 0
    buffer_load_dwordx4 v4, s[16:19], s34 offen lds
    s_add_u32 s34, s35, 4096
    s_add_u32 m0, s36, 4160
    s_nop 0
    buffer_load_dwordx4 v3, s[24:27], s34 offen lds
    s_add_u32 s34, s32, 32768
    s_add_u32 m0, s33, 4096
    s_nop 0
    buffer_load_dwordx4 v4, s[16:19], s34 offen lds
    s_add_u32 s34, s35, 5120
    s_add_u32 m0, s36, 5200
    s_nop 0
    buffer_load_dwordx4 v3, s[24:27], s34 offen lds
    s_add_u32 s34, s32, 40960
    s_add_u32 m0, s33, 5120
    s_nop 0
    buffer_load_dwordx4 v4, s[16:19], s34 offen lds
    s_add_u32 s34, s35, 6144
    s_add_u32 m0, s36, 6240
    s_nop 0
    buffer_load_dwordx4 v3, s[24:27], s34 offen lds
    s_add_u32 s34, s32, 49152
    s_add_u32 m0, s33, 6144
    s_nop 0
    buffer_load_dwordx4 v4, s[16:19], s34 offen lds
    s_add_u32 s34, s35, 7168
    s_add_u32 m0, s36, 7280
    s_nop 0
    buffer_load_dwordx4 v3, s[24:27], s34 offen lds
    s_add_u32 s34, s32, 57344
    s_add_u32 m0, s33, 7168
    s_nop 0
    buffer_load_dwordx4 v4, s[16:19], s34 offen lds
    s_add_u32 s34, s35, 8192
    s_add_u32 m0, s36, 8320
    s_nop 0
    buffer_load_dwordx4 v3, s[24:27], s34 offen lds
    s_add_u32 s34, s32, 65536
    s_add_u32 m0, s33, 8192
    s_nop 0
    buffer_load_dwordx4 v4, s[16:19], s34 offen lds
    s_add_u32 s34, s35, 9216
    s_add_u32 m0, s36, 9360
    s_nop 0
    buffer_load_dwordx4 v3, s[24:27], s34 offen lds
    s_add_u32 s34, s32, 73728
    s_add_u32 m0, s33, 9216
    s_nop 0
    buffer_load_dwordx4 v4, s[16:19], s34 offen lds
    s_add_u32 s34, s35, 10240
    s_add_u32 m0, s36, 10400
    s_nop 0
    buffer_load_dwordx4 v3, s[24:27], s34 offen lds
    s_add_u32 s34, s32, 81920
    s_add_u32 m0, s33, 10240
    s_nop 0
    buffer_load_dwordx4 v4, s[16:19], s34 offen lds
    s_add_u32 s34, s35, 11264
    s_add_u32 m0, s36, 11440
    s_nop 0
    buffer_load_dwordx4 v3, s[24:27], s34 offen lds
    s_add_u32 s34, s32, 90112
    s_add_u32 m0, s33, 11264
    s_nop 0
    buffer_load_dwordx4 v4, s[16:19], s34 offen lds
    s_add_u32 s34, s35, 12288
    s_add_u32 m0, s36, 12480
    s_nop 0
    buffer_load_dwordx4 v3, s[24:27], s34 offen lds
    s_add_u32 s34, s32, 98304
    s_add_u32 m0, s33, 12288
    s_nop 0
    buffer_load_dwordx4 v4, s[16:19], s34 offen lds
    s_add_u32 s34, s35, 13312
    s_add_u32 m0, s36, 13520
    s_nop 0
    buffer_load_dwordx4 v3, s[24:27], s34 offen lds
    s_add_u32 s34, s32, 106496
    s_add_u32 m0, s33, 13312
    s_nop 0
    buffer_load_dwordx4 v4, s[16:19], s34 offen lds
    s_add_u32 s34, s35, 14336
    s_add_u32 m0, s36, 14560
    s_nop 0
    buffer_load_dwordx4 v3, s[24:27], s34 offen lds
    s_add_u32 s34, s32, 114688
    s_add_u32 m0, s33, 14336
    s_nop 0
    buffer_load_dwordx4 v4, s[16:19], s34 offen lds
    s_add_u32 s34, s35, 15360
    s_add_u32 m0, s36, 15600
    s_nop 0
    buffer_load_dwordx4 v3, s[24:27], s34 offen lds
    s_add_u32 s34, s32, 122880
    s_add_u32 m0, s33, 15360
    s_nop 0
    buffer_load_dwordx4 v4, s[16:19], s34 offen lds
    v_and_b32 v19, 31, v2
    v_lshrrev_b32 v20, 5, v2
    s_lshl_b32 s31, s21, 6
    s_lshl_b32 s35, s39, 5
    s_add_u32 s31, s31, s35
    v_add_u32 v21, s31, v19
    v_lshlrev_b32 v22, 10, v21
    s_lshl_b32 s37, s22, 7
    s_lshl_b32 s38, s40, 6
    s_add_u32 s37, s37, s38
    v_lshlrev_b32 v23, 3, v20
    v_add_u32 v23, s37, v23
    v_add_u32 v24, v22, v23
    v_lshl_add_u32 v24, v20, 3, v24
    buffer_load_dwordx4 v[32:35], v24, s[12:15], 0 offen offset:0
    buffer_load_dwordx4 v[36:39], v24, s[12:15], 0 offen offset:32
    buffer_load_dwordx2 v[40:41], v23, s[44:47], 0 offen offset:0
    buffer_load_dwordx2 v[42:43], v23, s[44:47], 0 offen offset:16
    buffer_load_dwordx2 v[44:45], v23, s[44:47], 0 offen offset:32
    buffer_load_dwordx2 v[46:47], v23, s[44:47], 0 offen offset:48
    v_add_u32 v26, s35, v19
    v_mul_u32_u24 v26, 1040, v26
    v_lshl_add_u32 v26, v20, 4, v26
    v_add_u32 v26, 65536, v26
    v_bfe_u32 v5, v2, 2, 2
    v_and_b32 v6, 3, v2
    v_bfe_u32 v7, v2, 4, 1
    v_lshl_add_u32 v25, v20, 3, v5
    v_lshlrev_b32 v25, 7, v25
    v_lshl_add_u32 v25, v7, 5, v25
    v_lshl_add_u32 v25, v6, 3, v25
    v_lshrrev_b32 v5, 1, v5
    v_xor_b32 v5, s40, v5
    v_lshl_add_u32 v25, v5, 6, v25
    v_mov_b32 v48, 0
    v_mov_b32 v49, 0
    v_mov_b32 v50, 0
    v_mov_b32 v51, 0
    v_mov_b32 v52, 0
    v_mov_b32 v53, 0
    v_mov_b32 v54, 0
    v_mov_b32 v55, 0
    v_mov_b32 v56, 0
    v_mov_b32 v57, 0
    v_mov_b32 v58, 0
    v_mov_b32 v59, 0
    v_mov_b32 v60, 0
    v_mov_b32 v61, 0
    v_mov_b32 v62, 0
    v_mov_b32 v63, 0
    s_waitcnt vmcnt(6)
    s_barrier
    ds_read_b128 v[68:71], v26 offset:0
    ds_read_b64_tr_b16 v[64:65], v25 offset:0
    ds_read_b64_tr_b16 v[66:67], v25 offset:512
    ds_read_b128 v[76:79], v26 offset:32
    ds_read_b64_tr_b16 v[72:73], v25 offset:2048
    ds_read_b64_tr_b16 v[74:75], v25 offset:2560
    ds_read_b128 v[84:87], v26 offset:64
    ds_read_b64_tr_b16 v[80:81], v25 offset:4096
    ds_read_b64_tr_b16 v[82:83], v25 offset:4608
    ds_read_b128 v[92:95], v26 offset:96
    ds_read_b64_tr_b16 v[88:89], v25 offset:6144
    ds_read_b64_tr_b16 v[90:91], v25 offset:6656
    s_waitcnt lgkmcnt(9)
    v_mfma_f32_32x32x16_bf16 v[48:63], v[64:67], v[68:71], v[48:63]
    ds_read_b128 v[68:71], v26 offset:128
    ds_read_b64_tr_b16 v[64:65], v25 offset:8192
    ds_read_b64_tr_b16 v[66:67], v25 offset:8704
    s_waitcnt lgkmcnt(9)
    v_mfma_f32_32x32x16_bf16 v[48:63], v[72:75], v[76:79], v[48:63]
    ds_read_b128 v[76:79], v26 offset:160
    ds_read_b64_tr_b16 v[72:73], v25 offset:10240
    ds_read_b64_tr_b16 v[74:75], v25 offset:10752
    s_waitcnt lgkmcnt(9)
    v_mfma_f32_32x32x16_bf16 v[48:63], v[80:83], v[84:87], v[48:63]
    ds_read_b128 v[84:87], v26 offset:192
    ds_read_b64_tr_b16 v[80:81], v25 offset:12288
    ds_read_b64_tr_b16 v[82:83], v25 offset:12800
    s_waitcnt lgkmcnt(9)
    v_mfma_f32_32x32x16_bf16 v[48:63], v[88:91], v[92:95], v[48:63]
    ds_read_b128 v[92:95], v26 offset:224
    ds_read_b64_tr_b16 v[88:89], v25 offset:14336
    ds_read_b64_tr_b16 v[90:91], v25 offset:14848
    s_waitcnt lgkmcnt(9)
    v_mfma_f32_32x32x16_bf16 v[48:63], v[64:67], v[68:71], v[48:63]
    ds_read_b128 v[68:71], v26 offset:256
    ds_read_b64_tr_b16 v[64:65], v25 offset:16384
    ds_read_b64_tr_b16 v[66:67], v25 offset:16896
    s_waitcnt lgkmcnt(9)
    v_mfma_f32_32x32x16_bf16 v[48:63], v[72:75], v[76:79], v[48:63]
    ds_read_b128 v[76:79], v26 offset:288
    ds_read_b64_tr_b16 v[72:73], v25 offset:18432
    ds_read_b64_tr_b16 v[74:75], v25 offset:18944
    s_waitcnt lgkmcnt(9)
    v_mfma_f32_32x32x16_bf16 v[48:63], v[80:83], v[84:87], v[48:63]
    ds_read_b128 v[84:87], v26 offset:320
    ds_read_b64_tr_b16 v[80:81], v25 offset:20480
    ds_read_b64_tr_b16 v[82:83], v25 offset:20992
    s_waitcnt lgkmcnt(9)
    v_mfma_f32_32x32x16_bf16 v[48:63], v[88:91], v[92:95], v[48:63]
    ds_read_b128 v[92:95], v26 offset:352
    ds_read_b64_tr_b16 v[88:89], v25 offset:22528
    ds_read_b64_tr_b16 v[90:91], v25 offset:23040
    s_waitcnt lgkmcnt(9)
    v_mfma_f32_32x32x16_bf16 v[48:63], v[64:67], v[68:71], v[48:63]
    ds_read_b128 v[68:71], v26 offset:384
    ds_read_b64_tr_b16 v[64:65], v25 offset:24576
    ds_read_b64_tr_b16 v[66:67], v25 offset:25088
    s_waitcnt lgkmcnt(9)
    v_mfma_f32_32x32x16_bf16 v[48:63], v[72:75], v[76:79], v[48:63]
    ds_read_b128 v[76:79], v26 offset:416
    ds_read_b64_tr_b16 v[72:73], v25 offset:26624
    ds_read_b64_tr_b16 v[74:75], v25 offset:27136
    s_waitcnt lgkmcnt(9)
    v_mfma_f32_32x32x16_bf16 v[48:63], v[80:83], v[84:87], v[48:63]
    ds_read_b128 v[84:87], v26 offset:448
    ds_read_b64_tr_b16 v[80:81], v25 offset:28672
    ds_read_b64_tr_b16 v[82:83], v25 offset:29184
    s_waitcnt lgkmcnt(9)
    v_mfma_f32_32x32x16_bf16 v[48:63], v[88:91], v[92:95], v[48:63]
    ds_read_b128 v[92:95], v26 offset:480
    ds_read_b64_tr_b16 v[88:89], v25 offset:30720
    ds_read_b64_tr_b16 v[90:91], v25 offset:31232
    s_waitcnt lgkmcnt(9)
    v_mfma_f32_32x32x16_bf16 v[48:63], v[64:67], v[68:71], v[48:63]
    ds_read_b128 v[68:71], v26 offset:512
    ds_read_b64_tr_b16 v[64:65], v25 offset:32768
    ds_read_b64_tr_b16 v[66:67], v25 offset:33280
    s_waitcnt lgkmcnt(9)
    v_mfma_f32_32x32x16_bf16 v[48:63], v[72:75], v[76:79], v[48:63]
    ds_read_b128 v[76:79], v26 offset:544
    ds_read_b64_tr_b16 v[72:73], v25 offset:34816
    ds_read_b64_tr_b16 v[74:75], v25 offset:35328
    s_waitcnt lgkmcnt(9)
    v_mfma_f32_32x32x16_bf16 v[48:63], v[80:83], v[84:87], v[48:63]
    ds_read_b128 v[84:87], v26 offset:576
    ds_read_b64_tr_b16 v[80:81], v25 offset:36864
    ds_read_b64_tr_b16 v[82:83], v25 offset:37376
    s_waitcnt lgkmcnt(9)
    v_mfma_f32_32x32x16_bf16 v[48:63], v[88:91], v[92:95], v[48:63]
    ds_read_b128 v[92:95], v26 offset:608
    ds_read_b64_tr_b16 v[88:89], v25 offset:38912
    ds_read_b64_tr_b16 v[90:91], v25 offset:39424
    s_waitcnt lgkmcnt(9)
    v_mfma_f32_32x32x16_bf16 v[48:63], v[64:67], v[68:71], v[48:63]
    ds_read_b128 v[68:71], v26 offset:640
    ds_read_b64_tr_b16 v[64:65], v25 offset:40960
    ds_read_b64_tr_b16 v[66:67], v25 offset:41472
    s_waitcnt lgkmcnt(9)
    v_mfma_f32_32x32x16_bf16 v[48:63], v[72:75], v[76:79], v[48:63]
    ds_read_b128 v[76:79], v26 offset:672
    ds_read_b64_tr_b16 v[72:73], v25 offset:43008
    ds_read_b64_tr_b16 v[74:75], v25 offset:43520
    s_waitcnt lgkmcnt(9)
    v_mfma_f32_32x32x16_bf16 v[48:63], v[80:83], v[84:87], v[48:63]
    ds_read_b128 v[84:87], v26 offset:704
    ds_read_b64_tr_b16 v[80:81], v25 offset:45056
    ds_read_b64_tr_b16 v[82:83], v25 offset:45568
    s_waitcnt lgkmcnt(9)
    v_mfma_f32_32x32x16_bf16 v[48:63], v[88:91], v[92:95], v[48:63]
    ds_read_b128 v[92:95], v26 offset:736
    ds_read_b64_tr_b16 v[88:89], v25 offset:47104
    ds_read_b64_tr_b16 v[90:91], v25 offset:47616
    s_waitcnt lgkmcnt(9)
    v_mfma_f32_32x32x16_bf16 v[48:63], v[64:67], v[68:71], v[48:63]
    ds_read_b128 v[68:71], v26 offset:768
    ds_read_b64_tr_b16 v[64:65], v25 offset:49152
    ds_read_b64_tr_b16 v[66:67], v25 offset:49664
    s_waitcnt lgkmcnt(9)
    v_mfma_f32_32x32x16_bf16 v[48:63], v[72:75], v[76:79], v[48:63]
    ds_read_b128 v[76:79], v26 offset:800
    ds_read_b64_tr_b16 v[72:73], v25 offset:51200
    ds_read_b64_tr_b16 v[74:75], v25 offset:51712
    s_waitcnt lgkmcnt(9)
    v_mfma_f32_32x32x16_bf16 v[48:63], v[80:83], v[84:87], v[48:63]
    ds_read_b128 v[84:87], v26 offset:832
    ds_read_b64_tr_b16 v[80:81], v25 offset:53248
    ds_read_b64_tr_b16 v[82:83], v25 offset:53760
    s_waitcnt lgkmcnt(9)
    v_mfma_f32_32x32x16_bf16 v[48:63], v[88:91], v[92:95], v[48:63]
    ds_read_b128 v[92:95], v26 offset:864
    ds_read_b64_tr_b16 v[88:89], v25 offset:55296
    ds_read_b64_tr_b16 v[90:91], v25 offset:55808
    s_waitcnt lgkmcnt(9)
    v_mfma_f32_32x32x16_bf16 v[48:63], v[64:67], v[68:71], v[48:63]
    ds_read_b128 v[68:71], v26 offset:896
    ds_read_b64_tr_b16 v[64:65], v25 offset:57344
    ds_read_b64_tr_b16 v[66:67], v25 offset:57856
    s_waitcnt lgkmcnt(9)
    v_mfma_f32_32x32x16_bf16 v[48:63], v[72:75], v[76:79], v[48:63]
    ds_read_b128 v[76:79], v26 offset:928
    ds_read_b64_tr_b16 v[72:73], v25 offset:59392
    ds_read_b64_tr_b16 v[74:75], v25 offset:59904
    s_waitcnt lgkmcnt(9)
    v_mfma_f32_32x32x16_bf16 v[48:63], v[80:83], v[84:87], v[48:63]
    ds_read_b128 v[84:87], v26 offset:960
    ds_read_b64_tr_b16 v[80:81], v25 offset:61440
    ds_read_b64_tr_b16 v[82:83], v25 offset:61952
    s_waitcnt lgkmcnt(9)
    v_mfma_f32_32x32x16_bf16 v[48:63], v[88:91], v[92:95], v[48:63]
    ds_read_b128 v[92:95], v26 offset:992
    ds_read_b64_tr_b16 v[88:89], v25 offset:63488
    ds_read_b64_tr_b16 v[90:91], v25 offset:64000
    s_waitcnt lgkmcnt(9)
    v_mfma_f32_32x32x16_bf16 v[48:63], v[64:67], v[68:71], v[48:63]
    s_waitcnt lgkmcnt(6)
    v_mfma_f32_32x32x16_bf16 v[48:63], v[72:75], v[76:79], v[48:63]
    s_waitcnt lgkmcnt(3)
    v_mfma_f32_32x32x16_bf16 v[48:63], v[80:83], v[84:87], v[48:63]
    s_waitcnt lgkmcnt(0)
    v_mfma_f32_32x32x16_bf16 v[48:63], v[88:91], v[92:95], v[48:63]
    s_mov_b32 s41, 0x3f803f80
    v_mov_b32 v8, s41
    v_mov_b32 v9, 0
    v_mov_b32 v10, 0
    v_mov_b32 v11, 0
    s_waitcnt vmcnt(0)
    v_permlane32_swap_b32 v32, v34
    v_permlane32_swap_b32 v33, v35
    v_permlane32_swap_b32 v36, v38
    v_permlane32_swap_b32 v37, v39
    s_nop 7
    v_cvt_pk_bf16_f32 v12, v48, v49
    v_lshlrev_b32 v13, 16, v12
    v_and_b32 v14, 0xffff0000, v12
    v_lshlrev_b32 v15, 16, v32
    v_and_b32 v16, 0xffff0000, v32
    v_add_f32 v13, v13, v15
    v_add_f32 v14, v14, v16
    v_cvt_pk_bf16_f32 v32, v13, v14
    v_dot2_f32_bf16 v9, v32, v8, v9
    v_dot2_f32_bf16 v10, v32, v32, v10
    v_dot2_f32_bf16 v11, v32, v40, v11
    v_cvt_pk_bf16_f32 v12, v50, v51
    v_lshlrev_b32 v13, 16, v12
    v_and_b32 v14, 0xffff0000, v12
    v_lshlrev_b32 v15, 16, v33
    v_and_b32 v16, 0xffff0000, v33
    v_add_f32 v13, v13, v15
    v_add_f32 v14, v14, v16
    v_cvt_pk_bf16_f32 v33, v13, v14
    v_dot2_f32_bf16 v9, v33, v8, v9
    v_dot2_f32_bf16 v10, v33, v33, v10
    v_dot2_f32_bf16 v11, v33, v41, v11
    v_cvt_pk_bf16_f32 v12, v52, v53
    v_lshlrev_b32 v13, 16, v12
    v_and_b32 v14, 0xffff0000, v12
    v_lshlrev_b32 v15, 16, v34
    v_and_b32 v16, 0xffff0000, v34
    v_add_f32 v13, v13, v15
    v_add_f32 v14, v14, v16
    v_cvt_pk_bf16_f32 v34, v13, v14
    v_dot2_f32_bf16 v9, v34, v8, v9
    v_dot2_f32_bf16 v10, v34, v34, v10
    v_dot2_f32_bf16 v11, v34, v42, v11
    v_cvt_pk_bf16_f32 v12, v54, v55
    v_lshlrev_b32 v13, 16, v12
    v_and_b32 v14, 0xffff0000, v12
    v_lshlrev_b32 v15, 16, v35
    v_and_b32 v16, 0xffff0000, v35
    v_add_f32 v13, v13, v15
    v_add_f32 v14, v14, v16
    v_cvt_pk_bf16_f32 v35, v13, v14
    v_dot2_f32_bf16 v9, v35, v8, v9
    v_dot2_f32_bf16 v10, v35, v35, v10
    v_dot2_f32_bf16 v11, v35, v43, v11
    v_cvt_pk_bf16_f32 v12, v56, v57
    v_lshlrev_b32 v13, 16, v12
    v_and_b32 v14, 0xffff0000, v12
    v_lshlrev_b32 v15, 16, v36
    v_and_b32 v16, 0xffff0000, v36
    v_add_f32 v13, v13, v15
    v_add_f32 v14, v14, v16
    v_cvt_pk_bf16_f32 v36, v13, v14
    v_dot2_f32_bf16 v9, v36, v8, v9
    v_dot2_f32_bf16 v10, v36, v36, v10
    v_dot2_f32_bf16 v11, v36, v44, v11
    v_cvt_pk_bf16_f32 v12, v58, v59
    v_lshlrev_b32 v13, 16, v12
    v_and_b32 v14, 0xffff0000, v12
    v_lshlrev_b32 v15, 16, v37
    v_and_b32 v16, 0xffff0000, v37
    v_add_f32 v13, v13, v15
    v_add_f32 v14, v14, v16
    v_cvt_pk_bf16_f32 v37, v13, v14
    v_dot2_f32_bf16 v9, v37, v8, v9
    v_dot2_f32_bf16 v10, v37, v37, v10
    v_dot2_f32_bf16 v11, v37, v45, v11
    v_cvt_pk_bf16_f32 v12, v60, v61
    v_lshlrev_b32 v13, 16, v12
    v_and_b32 v14, 0xffff0000, v12
    v_lshlrev_b32 v15, 16, v38
    v_and_b32 v16, 0xffff0000, v38
    v_add_f32 v13, v13, v15
    v_add_f32 v14, v14, v16
    v_cvt_pk_bf16_f32 v38, v13, v14
    v_dot2_f32_bf16 v9, v38, v8, v9
    v_dot2_f32_bf16 v10, v38, v38, v10
    v_dot2_f32_bf16 v11, v38, v46, v11
    v_cvt_pk_bf16_f32 v12, v62, v63
    v_lshlrev_b32 v13, 16, v12
    v_and_b32 v14, 0xffff0000, v12
    v_lshlrev_b32 v15, 16, v39
    v_and_b32 v16, 0xffff0000, v39
    v_add_f32 v13, v13, v15
    v_add_f32 v14, v14, v16
    v_cvt_pk_bf16_f32 v39, v13, v14
    v_dot2_f32_bf16 v9, v39, v8, v9
    v_dot2_f32_bf16 v10, v39, v39, v10
    v_dot2_f32_bf16 v11, v39, v47, v11
    s_mov_b32 s36, 0x800000
    s_nop 1
    v_permlane32_swap_b32 v32, v34
    v_permlane32_swap_b32 v33, v35
    v_permlane32_swap_b32 v36, v38
    v_permlane32_swap_b32 v37, v39
    buffer_store_dwordx4 v[32:35], v24, s[24:27], s36 offen offset:0
    buffer_store_dwordx4 v[36:39], v24, s[24:27], s36 offen offset:32
    v_mov_b32 v12, v9
    v_mov_b32 v13, v10
    v_mov_b32 v14, v11
    s_nop 1
    v_permlane32_swap_b32 v9, v12
    v_permlane32_swap_b32 v10, v13
    v_permlane32_swap_b32 v11, v14
    s_nop 1
    v_add_f32 v9, v9, v12
    v_add_f32 v10, v10, v13
    v_add_f32 v11, v11, v14
    v_lshlrev_b32 v15, 2, v21
    s_mov_b64 exec, 0xffffffff
    s_mov_b32 s36, 0xa00000
    buffer_atomic_add_f32 v9, v15, s[24:27], s36 offen
    s_mov_b32 s36, 0xa02000
    buffer_atomic_add_f32 v10, v15, s[24:27], s36 offen
    s_mov_b32 s36, 0xa04000
    buffer_atomic_add_f32 v11, v15, s[24:27], s36 offen
K3_END:
    s_endpgm
.globl k4_kernel
.p2align 8
.type k4_kernel,@function
k4_kernel:
    s_cmp_ge_u32 s2, 88
    s_cbranch_scc1 K4_END
    s_load_dwordx2 s[4:5], s[0:1], 80
    s_load_dwordx4 s[8:11], s[0:1], 64
    s_load_dwordx8 s[44:51], s[0:1], 32
    v_lshrrev_b32 v1, 6, v0
    v_and_b32 v2, 63, v0
    s_nop 0
    v_readfirstlane_b32 s20, v1
    s_waitcnt lgkmcnt(0)
    s_mov_b32 s12, s4
    s_mov_b32 s13, s5
    s_mov_b32 s14, 0x1000000
    s_mov_b32 s15, 0x00020000
    s_mov_b32 s16, s8
    s_mov_b32 s17, s9
    s_mov_b32 s18, 0x200000
    s_mov_b32 s19, 0x00020000
    s_mov_b32 s24, s44
    s_mov_b32 s25, s45
    s_mov_b32 s26, 0x400
    s_mov_b32 s27, 0x00020000
    s_mov_b32 s28, s46
    s_mov_b32 s29, s47
    s_mov_b32 s30, 0x1c0000
    s_mov_b32 s31, 0x00020000
    s_mov_b32 s32, s48
    s_mov_b32 s33, s49
    s_mov_b32 s34, 0x1c0000
    s_mov_b32 s35, 0x00020000
    s_mov_b32 s36, s50
    s_mov_b32 s37, s51
    s_mov_b32 s38, 0x1c0000
    s_mov_b32 s39, 0x00020000
    s_mov_b32 s40, s10
    s_mov_b32 s41, s11
    s_mov_b32 s42, 0x100
    s_mov_b32 s43, 0x00020000
    v_lshlrev_b32 v7, 2, v0
    v_mov_b32 v3, 0
    v_mov_b32 v6, 0
    v_mov_b32 v11, 0
    s_mov_b32 s52, 0xa00000
    s_mov_b32 s53, 0xa02000
    s_mov_b32 s54, 0x800000
    s_mov_b32 s67, 0xa04000
    v_add_u32 v8, 4096, v7
    buffer_load_dword v64, v7, s[12:15], s52 offen
    buffer_load_dword v68, v8, s[12:15], s52 offen
    buffer_load_dword v65, v7, s[12:15], s53 offen
    buffer_load_dword v69, v8, s[12:15], s53 offen
    buffer_load_dword v66, v7, s[12:15], s67 offen
    buffer_load_dword v70, v8, s[12:15], s67 offen
    s_mov_b32 s55, 0xa08000
    s_load_dword s66, s[4:5], s55
    s_cmp_lt_u32 s2, 56
    s_cbranch_scc1 K4_LF
    s_sub_u32 s21, s2, 56
    s_lshl_b32 s21, s21, 6
    s_lshl_b32 s22, s20, 2
    s_add_u32 s21, s21, s22
    v_lshrrev_b32 v4, 4, v2
    v_and_b32 v5, 15, v2
    v_add_u32 v6, s21, v4
    v_lshlrev_b32 v3, 10, v6
    v_lshl_add_u32 v3, v5, 4, v3
    v_lshlrev_b32 v9, 2, v6
    buffer_load_dword v72, v9, s[12:15], s52 offen
    buffer_load_dword v73, v9, s[12:15], s53 offen
    buffer_load_dwordx4 v[80:83], v3, s[12:15], s54 offen offset:0
    buffer_load_dwordx4 v[84:87], v3, s[12:15], s54 offen offset:256
    buffer_load_dwordx4 v[88:91], v3, s[12:15], s54 offen offset:512
    buffer_load_dwordx4 v[92:95], v3, s[12:15], s54 offen offset:768
    s_waitcnt vmcnt(6) lgkmcnt(0)
    s_branch K4_TOP
K4_LF:
    s_waitcnt vmcnt(0) lgkmcnt(0)
K4_TOP:
    s_mov_b32 s56, 0xfffff800
    v_mul_f32 v18, 0x3b000000, v64
    v_mul_f32 v19, 0x3b000000, v65
    v_fma_f32 v19, -v18, v18, v19
    v_max_f32 v19, 0, v19
    v_add_f32 v19, 0x3727c5ac, v19
    v_rsq_f32 v19, v19
    v_fma_f32 v22, -v18, s66, v66
    v_sub_u32 v23, 2047, v0
    v_mul_f32 v22, v22, v19
    v_ashrrev_i32 v20, 31, v22
    v_or_b32 v20, 0x80000000, v20
    v_xor_b32 v22, v22, v20
    v_and_or_b32 v22, v22, s56, v23
    v_mul_f32 v26, 0x3b000000, v68
    v_mul_f32 v27, 0x3b000000, v69
    v_fma_f32 v27, -v26, v26, v27
    v_max_f32 v27, 0, v27
    v_add_f32 v27, 0x3727c5ac, v27
    v_rsq_f32 v27, v27
    v_fma_f32 v30, -v26, s66, v70
    v_sub_u32 v31, 1023, v0
    v_mul_f32 v30, v30, v27
    v_ashrrev_i32 v28, 31, v30
    v_or_b32 v28, 0x80000000, v28
    v_xor_b32 v30, v30, v28
    v_and_or_b32 v30, v30, s56, v31
    v_max_u32 v16, v22, v30
    v_min_u32 v17, v22, v30
    s_nop 1
    v_mov_b32_dpp v18, v16 row_ror:8 row_mask:0xf bank_mask:0xf
    v_mov_b32_dpp v19, v17 row_ror:8 row_mask:0xf bank_mask:0xf
    v_min_u32 v20, v16, v18
    v_max_u32 v16, v16, v18
    v_max3_u32 v17, v17, v19, v20
    s_nop 1
    v_mov_b32_dpp v18, v16 row_ror:4 row_mask:0xf bank_mask:0xf
    v_mov_b32_dpp v19, v17 row_ror:4 row_mask:0xf bank_mask:0xf
    v_min_u32 v20, v16, v18
    v_max_u32 v16, v16, v18
    v_max3_u32 v17, v17, v19, v20
    s_nop 1
    v_mov_b32_dpp v18, v16 row_ror:2 row_mask:0xf bank_mask:0xf
    v_mov_b32_dpp v19, v17 row_ror:2 row_mask:0xf bank_mask:0xf
    v_min_u32 v20, v16, v18
    v_max_u32 v16, v16, v18
    v_max3_u32 v17, v17, v19, v20
    s_nop 1
    v_mov_b32_dpp v18, v16 row_ror:1 row_mask:0xf bank_mask:0xf
    v_mov_b32_dpp v19, v17 row_ror:1 row_mask:0xf bank_mask:0xf
    v_min_u32 v20, v16, v18
    v_max_u32 v16, v16, v18
    v_max3_u32 v17, v17, v19, v20
    v_lshrrev_b32 v18, 4, v0
    v_lshlrev_b32 v18, 3, v18
    ds_write_b64 v18, v[16:17]
    s_waitcnt lgkmcnt(0)
    s_barrier
    v_lshlrev_b32 v18, 3, v2
    ds_read_b64 v[16:17], v18
    s_waitcnt lgkmcnt(0)
    s_nop 1
    v_mov_b32_dpp v18, v16 row_ror:8 row_mask:0xf bank_mask:0xf
    v_mov_b32_dpp v19, v17 row_ror:8 row_mask:0xf bank_mask:0xf
    v_min_u32 v20, v16, v18
    v_max_u32 v16, v16, v18
    v_max3_u32 v17, v17, v19, v20
    s_nop 1
    v_mov_b32_dpp v18, v16 row_ror:4 row_mask:0xf bank_mask:0xf
    v_mov_b32_dpp v19, v17 row_ror:4 row_mask:0xf bank_mask:0xf
    v_min_u32 v20, v16, v18
    v_max_u32 v16, v16, v18
    v_max3_u32 v17, v17, v19, v20
    s_nop 1
    v_mov_b32_dpp v18, v16 row_ror:2 row_mask:0xf bank_mask:0xf
    v_mov_b32_dpp v19, v17 row_ror:2 row_mask:0xf bank_mask:0xf
    v_min_u32 v20, v16, v18
    v_max_u32 v16, v16, v18
    v_max3_u32 v17, v17, v19, v20
    s_nop 1
    v_mov_b32_dpp v18, v16 row_ror:1 row_mask:0xf bank_mask:0xf
    v_mov_b32_dpp v19, v17 row_ror:1 row_mask:0xf bank_mask:0xf
    v_min_u32 v20, v16, v18
    v_max_u32 v16, v16, v18
    v_max3_u32 v17, v17, v19, v20
    s_nop 0
    v_readlane_b32 s56, v16, 0
    v_readlane_b32 s57, v17, 0
    v_readlane_b32 s58, v16, 16
    v_readlane_b32 s59, v17, 16
    v_readlane_b32 s60, v16, 32
    v_readlane_b32 s61, v17, 32
    v_readlane_b32 s62, v16, 48
    v_readlane_b32 s63, v17, 48
    s_min_u32 s64, s56, s58
    s_max_u32 s65, s57, s59
    s_max_u32 s56, s56, s58
    s_max_u32 s57, s64, s65
    s_min_u32 s64, s60, s62
    s_max_u32 s65, s61, s63
    s_max_u32 s60, s60, s62
    s_max_u32 s61, s64, s65
    s_min_u32 s64, s56, s60
    s_max_u32 s65, s57, s61
    s_max_u32 s56, s56, s60
    s_max_u32 s57, s64, s65
    s_and_b32 s56, s56, 0x7ff
    s_and_b32 s57, s57, 0x7ff
    s_sub_u32 s56, 2047, s56
    s_sub_u32 s57, 2047, s57
    s_cmp_lt_u32 s2, 56
    s_cbranch_scc1 K4_FFN
    s_waitcnt vmcnt(0)
    v_mul_f32 v12, 0x3b000000, v72
    v_mul_f32 v13, 0x3b000000, v73
    v_fma_f32 v13, -v12, v12, v13
    v_max_f32 v13, 0, v13
    v_cvt_pk_bf16_f32 v14, v12, v12
    v_lshlrev_b32 v14, 16, v14
    v_cvt_pk_bf16_f32 v13, v13, v13
    v_lshlrev_b32 v13, 16, v13
    v_add_f32 v13, 0x3727c5ac, v13
    v_cvt_pk_bf16_f32 v13, v13, v13
    v_lshlrev_b32 v13, 16, v13
    v_sqrt_f32 v13, v13
    s_nop 0
    v_cvt_pk_bf16_f32 v15, v13, v13
    v_lshlrev_b32 v15, 16, v15
    v_rcp_f32 v15, v15
    s_nop 0
    v_lshlrev_b32 v32, 16, v80
    v_and_b32 v33, 0xffff0000, v80
    v_sub_f32 v34, v32, v14
    v_sub_f32 v35, v33, v14
    v_cvt_pk_bf16_f32 v34, v34, v35
    v_and_b32 v35, 0xffff0000, v34
    v_lshlrev_b32 v34, 16, v34
    v_mul_f32 v34, v34, v15
    v_mul_f32 v35, v35, v15
    v_cvt_pk_bf16_f32 v34, v34, v35
    v_and_b32 v35, 0xffff0000, v34
    v_lshlrev_b32 v34, 16, v34
    v_add_f32 v34, v32, v34
    v_add_f32 v35, v33, v35
    v_cvt_pk_bf16_f32 v80, v34, v35
    v_lshlrev_b32 v32, 16, v81
    v_and_b32 v33, 0xffff0000, v81
    v_sub_f32 v34, v32, v14
    v_sub_f32 v35, v33, v14
    v_cvt_pk_bf16_f32 v34, v34, v35
    v_and_b32 v35, 0xffff0000, v34
    v_lshlrev_b32 v34, 16, v34
    v_mul_f32 v34, v34, v15
    v_mul_f32 v35, v35, v15
    v_cvt_pk_bf16_f32 v34, v34, v35
    v_and_b32 v35, 0xffff0000, v34
    v_lshlrev_b32 v34, 16, v34
    v_add_f32 v34, v32, v34
    v_add_f32 v35, v33, v35
    v_cvt_pk_bf16_f32 v81, v34, v35
    v_lshlrev_b32 v32, 16, v82
    v_and_b32 v33, 0xffff0000, v82
    v_sub_f32 v34, v32, v14
    v_sub_f32 v35, v33, v14
    v_cvt_pk_bf16_f32 v34, v34, v35
    v_and_b32 v35, 0xffff0000, v34
    v_lshlrev_b32 v34, 16, v34
    v_mul_f32 v34, v34, v15
    v_mul_f32 v35, v35, v15
    v_cvt_pk_bf16_f32 v34, v34, v35
    v_and_b32 v35, 0xffff0000, v34
    v_lshlrev_b32 v34, 16, v34
    v_add_f32 v34, v32, v34
    v_add_f32 v35, v33, v35
    v_cvt_pk_bf16_f32 v82, v34, v35
    v_lshlrev_b32 v32, 16, v83
    v_and_b32 v33, 0xffff0000, v83
    v_sub_f32 v34, v32, v14
    v_sub_f32 v35, v33, v14
    v_cvt_pk_bf16_f32 v34, v34, v35
    v_and_b32 v35, 0xffff0000, v34
    v_lshlrev_b32 v34, 16, v34
    v_mul_f32 v34, v34, v15
    v_mul_f32 v35, v35, v15
    v_cvt_pk_bf16_f32 v34, v34, v35
    v_and_b32 v35, 0xffff0000, v34
    v_lshlrev_b32 v34, 16, v34
    v_add_f32 v34, v32, v34
    v_add_f32 v35, v33, v35
    v_cvt_pk_bf16_f32 v83, v34, v35
    v_lshlrev_b32 v32, 16, v84
    v_and_b32 v33, 0xffff0000, v84
    v_sub_f32 v34, v32, v14
    v_sub_f32 v35, v33, v14
    v_cvt_pk_bf16_f32 v34, v34, v35
    v_and_b32 v35, 0xffff0000, v34
    v_lshlrev_b32 v34, 16, v34
    v_mul_f32 v34, v34, v15
    v_mul_f32 v35, v35, v15
    v_cvt_pk_bf16_f32 v34, v34, v35
    v_and_b32 v35, 0xffff0000, v34
    v_lshlrev_b32 v34, 16, v34
    v_add_f32 v34, v32, v34
    v_add_f32 v35, v33, v35
    v_cvt_pk_bf16_f32 v84, v34, v35
    v_lshlrev_b32 v32, 16, v85
    v_and_b32 v33, 0xffff0000, v85
    v_sub_f32 v34, v32, v14
    v_sub_f32 v35, v33, v14
    v_cvt_pk_bf16_f32 v34, v34, v35
    v_and_b32 v35, 0xffff0000, v34
    v_lshlrev_b32 v34, 16, v34
    v_mul_f32 v34, v34, v15
    v_mul_f32 v35, v35, v15
    v_cvt_pk_bf16_f32 v34, v34, v35
    v_and_b32 v35, 0xffff0000, v34
    v_lshlrev_b32 v34, 16, v34
    v_add_f32 v34, v32, v34
    v_add_f32 v35, v33, v35
    v_cvt_pk_bf16_f32 v85, v34, v35
    v_lshlrev_b32 v32, 16, v86
    v_and_b32 v33, 0xffff0000, v86
    v_sub_f32 v34, v32, v14
    v_sub_f32 v35, v33, v14
    v_cvt_pk_bf16_f32 v34, v34, v35
    v_and_b32 v35, 0xffff0000, v34
    v_lshlrev_b32 v34, 16, v34
    v_mul_f32 v34, v34, v15
    v_mul_f32 v35, v35, v15
    v_cvt_pk_bf16_f32 v34, v34, v35
    v_and_b32 v35, 0xffff0000, v34
    v_lshlrev_b32 v34, 16, v34
    v_add_f32 v34, v32, v34
    v_add_f32 v35, v33, v35
    v_cvt_pk_bf16_f32 v86, v34, v35
    v_lshlrev_b32 v32, 16, v87
    v_and_b32 v33, 0xffff0000, v87
    v_sub_f32 v34, v32, v14
    v_sub_f32 v35, v33, v14
    v_cvt_pk_bf16_f32 v34, v34, v35
    v_and_b32 v35, 0xffff0000, v34
    v_lshlrev_b32 v34, 16, v34
    v_mul_f32 v34, v34, v15
    v_mul_f32 v35, v35, v15
    v_cvt_pk_bf16_f32 v34, v34, v35
    v_and_b32 v35, 0xffff0000, v34
    v_lshlrev_b32 v34, 16, v34
    v_add_f32 v34, v32, v34
    v_add_f32 v35, v33, v35
    v_cvt_pk_bf16_f32 v87, v34, v35
    v_lshlrev_b32 v32, 16, v88
    v_and_b32 v33, 0xffff0000, v88
    v_sub_f32 v34, v32, v14
    v_sub_f32 v35, v33, v14
    v_cvt_pk_bf16_f32 v34, v34, v35
    v_and_b32 v35, 0xffff0000, v34
    v_lshlrev_b32 v34, 16, v34
    v_mul_f32 v34, v34, v15
    v_mul_f32 v35, v35, v15
    v_cvt_pk_bf16_f32 v34, v34, v35
    v_and_b32 v35, 0xffff0000, v34
    v_lshlrev_b32 v34, 16, v34
    v_add_f32 v34, v32, v34
    v_add_f32 v35, v33, v35
    v_cvt_pk_bf16_f32 v88, v34, v35
    v_lshlrev_b32 v32, 16, v89
    v_and_b32 v33, 0xffff0000, v89
    v_sub_f32 v34, v32, v14
    v_sub_f32 v35, v33, v14
    v_cvt_pk_bf16_f32 v34, v34, v35
    v_and_b32 v35, 0xffff0000, v34
    v_lshlrev_b32 v34, 16, v34
    v_mul_f32 v34, v34, v15
    v_mul_f32 v35, v35, v15
    v_cvt_pk_bf16_f32 v34, v34, v35
    v_and_b32 v35, 0xffff0000, v34
    v_lshlrev_b32 v34, 16, v34
    v_add_f32 v34, v32, v34
    v_add_f32 v35, v33, v35
    v_cvt_pk_bf16_f32 v89, v34, v35
    v_lshlrev_b32 v32, 16, v90
    v_and_b32 v33, 0xffff0000, v90
    v_sub_f32 v34, v32, v14
    v_sub_f32 v35, v33, v14
    v_cvt_pk_bf16_f32 v34, v34, v35
    v_and_b32 v35, 0xffff0000, v34
    v_lshlrev_b32 v34, 16, v34
    v_mul_f32 v34, v34, v15
    v_mul_f32 v35, v35, v15
    v_cvt_pk_bf16_f32 v34, v34, v35
    v_and_b32 v35, 0xffff0000, v34
    v_lshlrev_b32 v34, 16, v34
    v_add_f32 v34, v32, v34
    v_add_f32 v35, v33, v35
    v_cvt_pk_bf16_f32 v90, v34, v35
    v_lshlrev_b32 v32, 16, v91
    v_and_b32 v33, 0xffff0000, v91
    v_sub_f32 v34, v32, v14
    v_sub_f32 v35, v33, v14
    v_cvt_pk_bf16_f32 v34, v34, v35
    v_and_b32 v35, 0xffff0000, v34
    v_lshlrev_b32 v34, 16, v34
    v_mul_f32 v34, v34, v15
    v_mul_f32 v35, v35, v15
    v_cvt_pk_bf16_f32 v34, v34, v35
    v_and_b32 v35, 0xffff0000, v34
    v_lshlrev_b32 v34, 16, v34
    v_add_f32 v34, v32, v34
    v_add_f32 v35, v33, v35
    v_cvt_pk_bf16_f32 v91, v34, v35
    v_lshlrev_b32 v32, 16, v92
    v_and_b32 v33, 0xffff0000, v92
    v_sub_f32 v34, v32, v14
    v_sub_f32 v35, v33, v14
    v_cvt_pk_bf16_f32 v34, v34, v35
    v_and_b32 v35, 0xffff0000, v34
    v_lshlrev_b32 v34, 16, v34
    v_mul_f32 v34, v34, v15
    v_mul_f32 v35, v35, v15
    v_cvt_pk_bf16_f32 v34, v34, v35
    v_and_b32 v35, 0xffff0000, v34
    v_lshlrev_b32 v34, 16, v34
    v_add_f32 v34, v32, v34
    v_add_f32 v35, v33, v35
    v_cvt_pk_bf16_f32 v92, v34, v35
    v_lshlrev_b32 v32, 16, v93
    v_and_b32 v33, 0xffff0000, v93
    v_sub_f32 v34, v32, v14
    v_sub_f32 v35, v33, v14
    v_cvt_pk_bf16_f32 v34, v34, v35
    v_and_b32 v35, 0xffff0000, v34
    v_lshlrev_b32 v34, 16, v34
    v_mul_f32 v34, v34, v15
    v_mul_f32 v35, v35, v15
    v_cvt_pk_bf16_f32 v34, v34, v35
    v_and_b32 v35, 0xffff0000, v34
    v_lshlrev_b32 v34, 16, v34
    v_add_f32 v34, v32, v34
    v_add_f32 v35, v33, v35
    v_cvt_pk_bf16_f32 v93, v34, v35
    v_lshlrev_b32 v32, 16, v94
    v_and_b32 v33, 0xffff0000, v94
    v_sub_f32 v34, v32, v14
    v_sub_f32 v35, v33, v14
    v_cvt_pk_bf16_f32 v34, v34, v35
    v_and_b32 v35, 0xffff0000, v34
    v_lshlrev_b32 v34, 16, v34
    v_mul_f32 v34, v34, v15
    v_mul_f32 v35, v35, v15
    v_cvt_pk_bf16_f32 v34, v34, v35
    v_and_b32 v35, 0xffff0000, v34
    v_lshlrev_b32 v34, 16, v34
    v_add_f32 v34, v32, v34
    v_add_f32 v35, v33, v35
    v_cvt_pk_bf16_f32 v94, v34, v35
    v_lshlrev_b32 v32, 16, v95
    v_and_b32 v33, 0xffff0000, v95
    v_sub_f32 v34, v32, v14
    v_sub_f32 v35, v33, v14
    v_cvt_pk_bf16_f32 v34, v34, v35
    v_and_b32 v35, 0xffff0000, v34
    v_lshlrev_b32 v34, 16, v34
    v_mul_f32 v34, v34, v15
    v_mul_f32 v35, v35, v15
    v_cvt_pk_bf16_f32 v34, v34, v35
    v_and_b32 v35, 0xffff0000, v34
    v_lshlrev_b32 v34, 16, v34
    v_add_f32 v34, v32, v34
    v_add_f32 v35, v33, v35
    v_cvt_pk_bf16_f32 v95, v34, v35
    v_cmp_ne_u32 vcc, s56, v6
    v_cmp_ne_u32 s[60:61], s57, v6
    s_nop 1
    s_and_b64 s[60:61], s[60:61], vcc
    s_and_b64 exec, exec, s[60:61]
    s_cbranch_execz K4_END
    buffer_store_dwordx4 v[80:83], v3, s[16:19], 0 offen offset:0
    buffer_store_dwordx4 v[84:87], v3, s[16:19], 0 offen offset:256
    buffer_store_dwordx4 v[88:91], v3, s[16:19], 0 offen offset:512
    buffer_store_dwordx4 v[92:95], v3, s[16:19], 0 offen offset:768
    s_endpgm
K4_FFN:
    s_cmp_ge_u32 s20, 8
    s_cbranch_scc1 K4_NOXL
    s_cmp_lt_u32 s20, 4
    s_cselect_b32 s58, s56, s57
    s_lshl_b32 s59, s58, 2
    s_add_u32 s61, s59, s53
    s_add_u32 s59, s59, s52
    s_lshl_b32 s60, s58, 10
    s_add_u32 s60, s60, s54
    v_and_b32 v19, 255, v0
    v_lshlrev_b32 v20, 2, v19
    v_mov_b32 v21, 0
    buffer_load_dword v24, v21, s[12:15], s59 offen
    buffer_load_dword v25, v21, s[12:15], s61 offen
    buffer_load_dword v28, v20, s[12:15], s60 offen
    buffer_load_dword v30, v20, s[24:27], 0 offen
    v_lshrrev_b32 v41, 8, v0
K4_NOXL:
    s_barrier
    v_lshrrev_b32 v4, 4, v0
    v_and_b32 v5, 15, v0
    v_mul_u32_u24 v3, 3584, v4
    v_lshl_add_u32 v3, v5, 2, v3
    s_lshl_b32 s21, s2, 6
    v_add_u32 v3, s21, v3
    s_mov_b32 s55, 0
    buffer_load_dword v80, v3, s[28:31], s55 offen
    buffer_load_dword v88, v3, s[32:35], s55 offen
    s_mov_b32 s55, 229376
    buffer_load_dword v81, v3, s[28:31], s55 offen
    buffer_load_dword v89, v3, s[32:35], s55 offen
    s_mov_b32 s55, 458752
    buffer_load_dword v82, v3, s[28:31], s55 offen
    buffer_load_dword v90, v3, s[32:35], s55 offen
    s_mov_b32 s55, 688128
    buffer_load_dword v83, v3, s[28:31], s55 offen
    buffer_load_dword v91, v3, s[32:35], s55 offen
    s_mov_b32 s55, 917504
    buffer_load_dword v84, v3, s[28:31], s55 offen
    buffer_load_dword v92, v3, s[32:35], s55 offen
    s_mov_b32 s55, 1146880
    buffer_load_dword v85, v3, s[28:31], s55 offen
    buffer_load_dword v93, v3, s[32:35], s55 offen
    s_mov_b32 s55, 1376256
    buffer_load_dword v86, v3, s[28:31], s55 offen
    buffer_load_dword v94, v3, s[32:35], s55 offen
    s_mov_b32 s55, 1605632
    buffer_load_dword v87, v3, s[28:31], s55 offen
    buffer_load_dword v95, v3, s[32:35], s55 offen
    v_lshrrev_b32 v6, 8, v0
    v_and_b32 v9, 255, v0
    v_lshlrev_b32 v11, 13, v6
    v_lshl_add_u32 v11, v9, 2, v11
    s_lshl_b32 s21, s2, 15
    s_add_u32 s22, s21, 4096
    buffer_load_dword v96, v11, s[36:39], s21 offen offset:0
    buffer_load_dword v97, v11, s[36:39], s21 offen offset:1024
    buffer_load_dword v98, v11, s[36:39], s21 offen offset:2048
    buffer_load_dword v99, v11, s[36:39], s21 offen offset:3072
    buffer_load_dword v100, v11, s[36:39], s22 offen offset:0
    buffer_load_dword v101, v11, s[36:39], s22 offen offset:1024
    buffer_load_dword v102, v11, s[36:39], s22 offen offset:2048
    buffer_load_dword v103, v11, s[36:39], s22 offen offset:3072
    s_cmp_ge_u32 s20, 8
    s_cbranch_scc1 K4_NOXS
    s_waitcnt vmcnt(24)
    v_mul_f32 v32, 0x3b000000, v24
    v_mul_f32 v33, 0x3b000000, v25
    v_fma_f32 v33, -v32, v32, v33
    v_max_f32 v33, 0, v33
    v_cvt_pk_bf16_f32 v34, v32, v32
    v_lshlrev_b32 v34, 16, v34
    v_cvt_pk_bf16_f32 v33, v33, v33
    v_lshlrev_b32 v33, 16, v33
    v_add_f32 v33, 0x3727c5ac, v33
    v_cvt_pk_bf16_f32 v33, v33, v33
    v_lshlrev_b32 v33, 16, v33
    v_sqrt_f32 v33, v33
    s_nop 0
    v_cvt_pk_bf16_f32 v35, v33, v33
    v_lshlrev_b32 v35, 16, v35
    v_rcp_f32 v35, v35
    s_nop 0
    v_lshlrev_b32 v36, 16, v28
    v_and_b32 v37, 0xffff0000, v28
    v_sub_f32 v38, v36, v34
    v_sub_f32 v39, v37, v34
    v_cvt_pk_bf16_f32 v38, v38, v39
    v_and_b32 v39, 0xffff0000, v38
    v_lshlrev_b32 v38, 16, v38
    v_mul_f32 v38, v38, v35
    v_mul_f32 v39, v39, v35
    v_cvt_pk_bf16_f32 v38, v38, v39
    v_mov_b32 v40, 0
    v_dot2_f32_bf16 v40, v38, v30, v40
    v_lshlrev_b32 v42, 2, v41
    v_lshl_add_u32 v42, v19, 4, v42
    v_lshlrev_b32 v43, 16, v38
    v_and_b32 v44, 0xffff0000, v38
    ds_write_b32 v42, v43 offset:1024
    ds_write_b32 v42, v44 offset:1032
    v_lshlrev_b32 v45, 2, v0
    ds_write_b32 v45, v28 offset:5120
    s_nop 1
    v_add_f32_dpp v40, v40, v40 row_ror:8 row_mask:0xf bank_mask:0xf
    s_nop 1
    v_add_f32_dpp v40, v40, v40 row_ror:4 row_mask:0xf bank_mask:0xf
    s_nop 1
    v_add_f32_dpp v40, v40, v40 row_ror:2 row_mask:0xf bank_mask:0xf
    s_nop 1
    v_add_f32_dpp v40, v40, v40 row_ror:1 row_mask:0xf bank_mask:0xf
    v_lshrrev_b32 v45, 4, v0
    v_lshlrev_b32 v45, 2, v45
    ds_write_b32 v45, v40 offset:512
K4_NOXS:
    s_waitcnt lgkmcnt(0)
    s_barrier
    v_mov_b32 v104, 0
    v_mov_b32 v105, 0
    v_mov_b32 v106, 0
    v_mov_b32 v107, 0
    v_mov_b32 v108, 0
    v_mov_b32 v109, 0
    v_mov_b32 v110, 0
    v_mov_b32 v111, 0
    v_lshlrev_b32 v41, 3, v4
    ds_read_b64 v[48:49], v41 offset:1024
    ds_read_b64 v[50:51], v41 offset:1536
    ds_read_b64 v[52:53], v41 offset:2048
    ds_read_b64 v[54:55], v41 offset:2560
    ds_read_b64 v[56:57], v41 offset:3072
    ds_read_b64 v[58:59], v41 offset:3584
    ds_read_b64 v[60:61], v41 offset:4096
    ds_read_b64 v[62:63], v41 offset:4608
    s_waitcnt vmcnt(22) lgkmcnt(7)
    v_lshlrev_b32 v44, 16, v80
    v_and_b32 v45, 0xffff0000, v80
    v_fmac_f32 v104, v44, v48
    v_fmac_f32 v105, v45, v48
    v_fmac_f32 v106, v44, v49
    v_fmac_f32 v107, v45, v49
    v_lshlrev_b32 v46, 16, v88
    v_and_b32 v47, 0xffff0000, v88
    v_fmac_f32 v108, v46, v48
    v_fmac_f32 v109, v47, v48
    v_fmac_f32 v110, v46, v49
    v_fmac_f32 v111, v47, v49
    s_waitcnt vmcnt(20) lgkmcnt(6)
    v_lshlrev_b32 v44, 16, v81
    v_and_b32 v45, 0xffff0000, v81
    v_fmac_f32 v104, v44, v50
    v_fmac_f32 v105, v45, v50
    v_fmac_f32 v106, v44, v51
    v_fmac_f32 v107, v45, v51
    v_lshlrev_b32 v46, 16, v89
    v_and_b32 v47, 0xffff0000, v89
    v_fmac_f32 v108, v46, v50
    v_fmac_f32 v109, v47, v50
    v_fmac_f32 v110, v46, v51
    v_fmac_f32 v111, v47, v51
    s_waitcnt vmcnt(18) lgkmcnt(5)
    v_lshlrev_b32 v44, 16, v82
    v_and_b32 v45, 0xffff0000, v82
    v_fmac_f32 v104, v44, v52
    v_fmac_f32 v105, v45, v52
    v_fmac_f32 v106, v44, v53
    v_fmac_f32 v107, v45, v53
    v_lshlrev_b32 v46, 16, v90
    v_and_b32 v47, 0xffff0000, v90
    v_fmac_f32 v108, v46, v52
    v_fmac_f32 v109, v47, v52
    v_fmac_f32 v110, v46, v53
    v_fmac_f32 v111, v47, v53
    s_waitcnt vmcnt(16) lgkmcnt(4)
    v_lshlrev_b32 v44, 16, v83
    v_and_b32 v45, 0xffff0000, v83
    v_fmac_f32 v104, v44, v54
    v_fmac_f32 v105, v45, v54
    v_fmac_f32 v106, v44, v55
    v_fmac_f32 v107, v45, v55
    v_lshlrev_b32 v46, 16, v91
    v_and_b32 v47, 0xffff0000, v91
    v_fmac_f32 v108, v46, v54
    v_fmac_f32 v109, v47, v54
    v_fmac_f32 v110, v46, v55
    v_fmac_f32 v111, v47, v55
    s_waitcnt vmcnt(14) lgkmcnt(3)
    v_lshlrev_b32 v44, 16, v84
    v_and_b32 v45, 0xffff0000, v84
    v_fmac_f32 v104, v44, v56
    v_fmac_f32 v105, v45, v56
    v_fmac_f32 v106, v44, v57
    v_fmac_f32 v107, v45, v57
    v_lshlrev_b32 v46, 16, v92
    v_and_b32 v47, 0xffff0000, v92
    v_fmac_f32 v108, v46, v56
    v_fmac_f32 v109, v47, v56
    v_fmac_f32 v110, v46, v57
    v_fmac_f32 v111, v47, v57
    s_waitcnt vmcnt(12) lgkmcnt(2)
    v_lshlrev_b32 v44, 16, v85
    v_and_b32 v45, 0xffff0000, v85
    v_fmac_f32 v104, v44, v58
    v_fmac_f32 v105, v45, v58
    v_fmac_f32 v106, v44, v59
    v_fmac_f32 v107, v45, v59
    v_lshlrev_b32 v46, 16, v93
    v_and_b32 v47, 0xffff0000, v93
    v_fmac_f32 v108, v46, v58
    v_fmac_f32 v109, v47, v58
    v_fmac_f32 v110, v46, v59
    v_fmac_f32 v111, v47, v59
    s_waitcnt vmcnt(10) lgkmcnt(1)
    v_lshlrev_b32 v44, 16, v86
    v_and_b32 v45, 0xffff0000, v86
    v_fmac_f32 v104, v44, v60
    v_fmac_f32 v105, v45, v60
    v_fmac_f32 v106, v44, v61
    v_fmac_f32 v107, v45, v61
    v_lshlrev_b32 v46, 16, v94
    v_and_b32 v47, 0xffff0000, v94
    v_fmac_f32 v108, v46, v60
    v_fmac_f32 v109, v47, v60
    v_fmac_f32 v110, v46, v61
    v_fmac_f32 v111, v47, v61
    s_waitcnt vmcnt(8) lgkmcnt(0)
    v_lshlrev_b32 v44, 16, v87
    v_and_b32 v45, 0xffff0000, v87
    v_fmac_f32 v104, v44, v62
    v_fmac_f32 v105, v45, v62
    v_fmac_f32 v106, v44, v63
    v_fmac_f32 v107, v45, v63
    v_lshlrev_b32 v46, 16, v95
    v_and_b32 v47, 0xffff0000, v95
    v_fmac_f32 v108, v46, v62
    v_fmac_f32 v109, v47, v62
    v_fmac_f32 v110, v46, v63
    v_fmac_f32 v111, v47, v63
    v_lshlrev_b32 v41, 5, v0
    ds_write_b128 v41, v[104:107] offset:8192
    ds_write_b128 v41, v[108:111] offset:8208
    s_waitcnt lgkmcnt(0)
    s_barrier
    v_and_b32 v41, 127, v0
    v_lshrrev_b32 v42, 7, v0
    v_lshlrev_b32 v43, 12, v42
    v_lshl_add_u32 v43, v41, 2, v43
    ds_read_b32 v48, v43 offset:8192
    ds_read_b32 v49, v43 offset:8704
    ds_read_b32 v50, v43 offset:9216
    ds_read_b32 v51, v43 offset:9728
    ds_read_b32 v52, v43 offset:10240
    ds_read_b32 v53, v43 offset:10752
    ds_read_b32 v54, v43 offset:11264
    ds_read_b32 v55, v43 offset:11776
    s_waitcnt lgkmcnt(0)
    v_add_f32 v48, v48, v49
    v_add_f32 v48, v48, v50
    v_add_f32 v48, v48, v51
    v_add_f32 v48, v48, v52
    v_add_f32 v48, v48, v53
    v_add_f32 v48, v48, v54
    v_add_f32 v48, v48, v55
    v_lshlrev_b32 v43, 2, v0
    ds_write_b32 v43, v48 offset:40960
    s_waitcnt lgkmcnt(0)
    s_barrier
    s_cmp_lg_u32 s20, 0
    s_cbranch_scc1 K4_NS3
    v_lshrrev_b32 v41, 5, v2
    v_and_b32 v42, 31, v2
    v_lshrrev_b32 v43, 1, v42
    v_and_b32 v44, 1, v42
    v_lshlrev_b32 v45, 5, v43
    v_lshl_add_u32 v45, v41, 3, v45
    v_lshl_add_u32 v45, v44, 2, v45
    ds_read_b32 v48, v45 offset:40960
    ds_read_b32 v56, v45 offset:40976
    ds_read_b32 v49, v45 offset:41472
    ds_read_b32 v57, v45 offset:41488
    ds_read_b32 v50, v45 offset:41984
    ds_read_b32 v58, v45 offset:42000
    ds_read_b32 v51, v45 offset:42496
    ds_read_b32 v59, v45 offset:42512
    ds_read_b32 v52, v45 offset:43008
    ds_read_b32 v60, v45 offset:43024
    ds_read_b32 v53, v45 offset:43520
    ds_read_b32 v61, v45 offset:43536
    ds_read_b32 v54, v45 offset:44032
    ds_read_b32 v62, v45 offset:44048
    ds_read_b32 v55, v45 offset:44544
    ds_read_b32 v63, v45 offset:44560
    s_waitcnt lgkmcnt(0)
    v_add_f32 v48, v48, v49
    v_add_f32 v56, v56, v57
    v_add_f32 v48, v48, v50
    v_add_f32 v56, v56, v58
    v_add_f32 v48, v48, v51
    v_add_f32 v56, v56, v59
    v_add_f32 v48, v48, v52
    v_add_f32 v56, v56, v60
    v_add_f32 v48, v48, v53
    v_add_f32 v56, v56, v61
    v_add_f32 v48, v48, v54
    v_add_f32 v56, v56, v62
    v_add_f32 v48, v48, v55
    v_add_f32 v56, v56, v63
    v_cvt_pk_bf16_f32 v48, v48, v48
    v_lshlrev_b32 v48, 16, v48
    v_cvt_pk_bf16_f32 v56, v56, v56
    v_lshlrev_b32 v56, 16, v56
    v_mul_f32 v49, 0xbfb8aa3b, v48
    v_exp_f32 v49, v49
    s_nop 0
    v_add_f32 v49, 1.0, v49
    v_rcp_f32 v49, v49
    s_nop 0
    v_mul_f32 v49, v48, v49
    v_cvt_pk_bf16_f32 v49, v49, v49
    v_lshlrev_b32 v49, 16, v49
    v_mul_f32 v49, v49, v56
    v_cvt_pk_bf16_f32 v49, v49, v49
    v_lshlrev_b32 v49, 16, v49
    v_lshlrev_b32 v50, 3, v42
    v_lshl_add_u32 v50, v41, 2, v50
    ds_write_b32 v50, v49 offset:45056
    s_waitcnt lgkmcnt(0)
K4_NS3:
    s_barrier
    v_lshlrev_b32 v41, 6, v6
    ds_read_b64 v[48:49], v41 offset:45056
    ds_read_b64 v[50:51], v41 offset:45064
    ds_read_b64 v[52:53], v41 offset:45072
    ds_read_b64 v[54:55], v41 offset:45080
    ds_read_b64 v[56:57], v41 offset:45088
    ds_read_b64 v[58:59], v41 offset:45096
    ds_read_b64 v[60:61], v41 offset:45104
    ds_read_b64 v[62:63], v41 offset:45112
    v_mov_b32 v104, 0
    v_mov_b32 v105, 0
    v_mov_b32 v106, 0
    v_mov_b32 v107, 0
    s_waitcnt vmcnt(7) lgkmcnt(7)
    v_lshlrev_b32 v44, 16, v96
    v_and_b32 v45, 0xffff0000, v96
    v_fmac_f32 v104, v44, v48
    v_fmac_f32 v105, v45, v48
    v_fmac_f32 v106, v44, v49
    v_fmac_f32 v107, v45, v49
    s_waitcnt vmcnt(6) lgkmcnt(6)
    v_lshlrev_b32 v46, 16, v97
    v_and_b32 v47, 0xffff0000, v97
    v_fmac_f32 v104, v46, v50
    v_fmac_f32 v105, v47, v50
    v_fmac_f32 v106, v46, v51
    v_fmac_f32 v107, v47, v51
    s_waitcnt vmcnt(5) lgkmcnt(5)
    v_lshlrev_b32 v44, 16, v98
    v_and_b32 v45, 0xffff0000, v98
    v_fmac_f32 v104, v44, v52
    v_fmac_f32 v105, v45, v52
    v_fmac_f32 v106, v44, v53
    v_fmac_f32 v107, v45, v53
    s_waitcnt vmcnt(4) lgkmcnt(4)
    v_lshlrev_b32 v46, 16, v99
    v_and_b32 v47, 0xffff0000, v99
    v_fmac_f32 v104, v46, v54
    v_fmac_f32 v105, v47, v54
    v_fmac_f32 v106, v46, v55
    v_fmac_f32 v107, v47, v55
    s_waitcnt vmcnt(3) lgkmcnt(3)
    v_lshlrev_b32 v44, 16, v100
    v_and_b32 v45, 0xffff0000, v100
    v_fmac_f32 v104, v44, v56
    v_fmac_f32 v105, v45, v56
    v_fmac_f32 v106, v44, v57
    v_fmac_f32 v107, v45, v57
    s_waitcnt vmcnt(2) lgkmcnt(2)
    v_lshlrev_b32 v46, 16, v101
    v_and_b32 v47, 0xffff0000, v101
    v_fmac_f32 v104, v46, v58
    v_fmac_f32 v105, v47, v58
    v_fmac_f32 v106, v46, v59
    v_fmac_f32 v107, v47, v59
    s_waitcnt vmcnt(1) lgkmcnt(1)
    v_lshlrev_b32 v44, 16, v102
    v_and_b32 v45, 0xffff0000, v102
    v_fmac_f32 v104, v44, v60
    v_fmac_f32 v105, v45, v60
    v_fmac_f32 v106, v44, v61
    v_fmac_f32 v107, v45, v61
    s_waitcnt vmcnt(0) lgkmcnt(0)
    v_lshlrev_b32 v46, 16, v103
    v_and_b32 v47, 0xffff0000, v103
    v_fmac_f32 v104, v46, v62
    v_fmac_f32 v105, v47, v62
    v_fmac_f32 v106, v46, v63
    v_fmac_f32 v107, v47, v63
    v_lshlrev_b32 v41, 4, v0
    ds_write_b128 v41, v[104:107] offset:49152
    s_waitcnt lgkmcnt(0)
    s_barrier
    v_lshrrev_b32 v41, 9, v0
    v_and_b32 v42, 511, v0
    v_lshrrev_b32 v43, 1, v42
    v_and_b32 v44, 1, v42
    v_lshlrev_b32 v45, 4, v43
    v_lshl_add_u32 v45, v41, 3, v45
    v_lshl_add_u32 v45, v44, 2, v45
    ds_read_b32 v48, v45 offset:49152
    ds_read_b32 v49, v45 offset:53248
    ds_read_b32 v50, v45 offset:57344
    ds_read_b32 v51, v45 offset:61440
    s_waitcnt lgkmcnt(0)
    v_add_f32 v48, v48, v49
    v_add_f32 v50, v50, v51
    v_add_f32 v48, v48, v50
    v_lshlrev_b32 v46, 2, v0
    s_mov_b32 s58, 0xa10000
    buffer_atomic_add_f32 v48, v46, s[12:15], s58 offen
    s_waitcnt vmcnt(0)
    s_barrier
    s_cmp_lg_u32 s20, 0
    s_cbranch_scc1 K4_NCNT
    v_mov_b32 v48, 1
    v_mov_b32 v49, 0
    v_mov_b32 v50, 8064
    s_mov_b64 exec, 1
    buffer_atomic_add v48, v49, s[40:43], 0 offen sc0
    s_waitcnt vmcnt(0)
    ds_write_b32 v50, v48
    s_mov_b64 exec, -1
    s_waitcnt lgkmcnt(0)
K4_NCNT:
    s_barrier
    v_mov_b32 v50, 8064
    ds_read_b32 v48, v50
    s_waitcnt lgkmcnt(0)
    v_readfirstlane_b32 s59, v48
    s_cmp_lg_u32 s59, 55
    s_cbranch_scc1 K4_END
    v_mov_b32 v48, 0
    buffer_atomic_add_f32 v48, v46, s[12:15], s58 offen sc0
    v_lshlrev_b32 v47, 6, v41
    ds_read_b128 v[52:55], v47 offset:512
    ds_read_b128 v[56:59], v47 offset:528
    ds_read_b128 v[60:63], v47 offset:544
    ds_read_b128 v[64:67], v47 offset:560
    v_lshlrev_b32 v47, 3, v42
    v_lshl_add_u32 v47, v41, 2, v47
    ds_read_b32 v49, v47 offset:1024
    v_lshlrev_b32 v47, 1, v0
    ds_read_u16 v50, v47 offset:5120
    s_waitcnt lgkmcnt(0)
    v_add_f32 v52, v52, v53
    v_add_f32 v52, v52, v54
    v_add_f32 v52, v52, v55
    v_add_f32 v52, v52, v56
    v_add_f32 v52, v52, v57
    v_add_f32 v52, v52, v58
    v_add_f32 v52, v52, v59
    v_add_f32 v52, v52, v60
    v_add_f32 v52, v52, v61
    v_add_f32 v52, v52, v62
    v_add_f32 v52, v52, v63
    v_add_f32 v52, v52, v64
    v_add_f32 v52, v52, v65
    v_add_f32 v52, v52, v66
    v_add_f32 v52, v52, v67
    v_cvt_pk_bf16_f32 v52, v52, v52
    v_lshlrev_b32 v52, 16, v52
    v_mul_f32 v52, 0xbfb8aa3b, v52
    v_exp_f32 v52, v52
    s_nop 0
    v_add_f32 v52, 1.0, v52
    v_rcp_f32 v52, v52
    s_nop 0
    v_cvt_pk_bf16_f32 v52, v52, v52
    v_lshlrev_b32 v52, 16, v52
    v_lshlrev_b32 v50, 16, v50
    s_cmp_lt_u32 s20, 8
    s_cselect_b32 s60, s56, s57
    s_lshl_b32 s60, s60, 10
    v_lshlrev_b32 v51, 1, v42
    s_waitcnt vmcnt(0)
    v_cvt_pk_bf16_f32 v48, v48, v48
    v_lshlrev_b32 v48, 16, v48
    v_mul_f32 v48, v48, v52
    v_cvt_pk_bf16_f32 v48, v48, v48
    v_lshlrev_b32 v48, 16, v48
    v_add_f32 v48, v49, v48
    v_cvt_pk_bf16_f32 v48, v48, v48
    v_lshlrev_b32 v48, 16, v48
    v_add_f32 v48, v50, v48
    v_cvt_pk_bf16_f32 v48, v48, v48
    buffer_store_short v48, v51, s[16:19], s60 offen
K4_END:
    s_endpgm
.section .rodata,"a"
.p2align 6
.amdhsa_kernel k1_kernel
  .amdhsa_next_free_vgpr 128
  .amdhsa_next_free_sgpr 64
  .amdhsa_accum_offset 128
  .amdhsa_group_segment_fixed_size 0
  .amdhsa_kernarg_size 88
  .amdhsa_user_sgpr_count 2
  .amdhsa_user_sgpr_kernarg_segment_ptr 1
  .amdhsa_system_sgpr_workgroup_id_x 1
.end_amdhsa_kernel
.p2align 6
.amdhsa_kernel k2_kernel
  .amdhsa_next_free_vgpr 128
  .amdhsa_next_free_sgpr 64
  .amdhsa_accum_offset 128
  .amdhsa_group_segment_fixed_size 0
  .amdhsa_kernarg_size 88
  .amdhsa_user_sgpr_count 2
  .amdhsa_user_sgpr_kernarg_segment_ptr 1
  .amdhsa_system_sgpr_workgroup_id_x 1
.end_amdhsa_kernel
.p2align 6
.amdhsa_kernel k3_kernel
  .amdhsa_next_free_vgpr 96
  .amdhsa_next_free_sgpr 64
  .amdhsa_accum_offset 96
  .amdhsa_group_segment_fixed_size 0
  .amdhsa_kernarg_size 88
  .amdhsa_user_sgpr_count 2
  .amdhsa_user_sgpr_kernarg_segment_ptr 1
  .amdhsa_system_sgpr_workgroup_id_x 1
.end_amdhsa_kernel
.p2align 6
.amdhsa_kernel k4_kernel
  .amdhsa_next_free_vgpr 112
  .amdhsa_next_free_sgpr 96
  .amdhsa_accum_offset 112
  .amdhsa_group_segment_fixed_size 0
  .amdhsa_kernarg_size 88
  .amdhsa_user_sgpr_count 2
  .amdhsa_user_sgpr_kernarg_segment_ptr 1
  .amdhsa_system_sgpr_workgroup_id_x 1
.end_amdhsa_kernel
```
